```python
import torch

def _softmax(x, axis=-1):
    return torch.softmax(x, dim=axis)
def _gelu(x):
    return torch.nn.functional.gelu(x, approximate="tanh")
def _silu(x):
    return torch.nn.functional.silu(x)
def _sigmoid(x):
    return torch.sigmoid(x)
def _layernorm(x, axis=-1, eps=1e-5):
    m = x.mean(dim=axis, keepdim=True)
    v = x.var(dim=axis, keepdim=True, unbiased=False)
    return (x - m) / torch.sqrt(v + eps)
def _scatter_add(tgt, idx, src, axis=0):
    return tgt.clone().index_add_(axis, idx, src)
def _segment_sum(src, seg, n):
    out = torch.zeros((n,) + src.shape[1:], dtype=src.dtype)
    return out.index_add_(0, seg, src)
def _pad(x, pw):
    flat = tuple(v for pair in reversed(pw) for v in pair)
    return torch.nn.functional.pad(x, flat)

kernel_name = 'gated_mix__ssm_conv_s4__linear_attn_block__prompt'

def setup_inputs():

    _w = (lambda a: (lambda t: t.to(torch.bfloat16) if t.is_floating_point() else t)(torch.as_tensor(a)))
    def _A_setup():
        B, L, D, N = 1, 2048, 640, 192
        A_re = -(lambda _x: torch.exp(torch.as_tensor(_x)))((lambda *s: torch.randn(*s, dtype=torch.bfloat16) * 6.4)(D, N))
        A_im = torch.pi * (lambda *s: torch.randn(*s, dtype=torch.bfloat16) * 0.05)(D, N)
        B_re = (lambda *s: torch.randn(*s, dtype=torch.bfloat16) * 0.1)(D, N)
        B_im = (lambda *s: torch.randn(*s, dtype=torch.bfloat16) * 0.1)(D, N)
        C_re = (lambda *s: torch.randn(*s, dtype=torch.bfloat16) * 0.1)(D, N)
        C_im = (lambda *s: torch.randn(*s, dtype=torch.bfloat16) * 0.1)(D, N)
        log_dt = (lambda *s: torch.randn(*s, dtype=torch.bfloat16) * 0.05)(D) * 0.5 - 4.0
        Dskip = (lambda *s: torch.randn(*s, dtype=torch.bfloat16) * 0.05)(D)
        return {
            "u": _w((lambda *s: torch.randn(*s, dtype=torch.bfloat16) * 0.05)(B, L, D)),
            "A_re": _w(A_re),
            "A_im": _w(A_im),
            "B_re": _w(B_re),
            "B_im": _w(B_im),
            "C_re": _w(C_re),
            "C_im": _w(C_im),
            "log_dt": _w(log_dt),
            "Dskip": _w(Dskip),
        }
    _A_in = _A_setup()

    def _B_setup():
        B, S, D = 1, 2048, 640
        return {
            "x": _w((lambda *s: torch.randn(*s, dtype=torch.bfloat16) * 0.05)(B, S, D)),
            "wqkv": _w((lambda *s: torch.randn(*s, dtype=torch.bfloat16) * 0.4)(D, 3 * D)),
            "wo": _w((lambda *s: torch.randn(*s, dtype=torch.bfloat16) * 0.05)(D, D)),
        }
    _B_in = _B_setup()

    return {
        "A_u": _A_in["u"],
        "A_A_re": _A_in["A_re"],
        "A_A_im": _A_in["A_im"],
        "A_B_re": _A_in["B_re"],
        "A_B_im": _A_in["B_im"],
        "A_C_re": _A_in["C_re"],
        "A_C_im": _A_in["C_im"],
        "A_log_dt": _A_in["log_dt"],
        "A_Dskip": _A_in["Dskip"],
        "B_x": _B_in["x"],
        "B_wqkv": _B_in["wqkv"],
        "B_wo": _B_in["wo"],
        "gate_w": _w((lambda *s: torch.randn(*s, dtype=torch.bfloat16) * 0.05)(640) * 16.0),
    }

def reference(A_u, A_A_re, A_A_im, A_B_re, A_B_im, A_C_re, A_C_im, A_log_dt, A_Dskip, B_x, B_wqkv, B_wo, gate_w):
    def _A_ref(u, A_re, A_im, B_re, B_im, C_re, C_im, log_dt, Dskip):
        Bsz, L, D = u.shape
        dt = torch.exp(log_dt)[:, None]
        A = A_re + 1j * A_im
        Bc = B_re + 1j * B_im
        Cc = C_re + 1j * C_im
        logdA = dt * A
        dB = dt * Bc
        l = (lambda x, dt: x.to(dt))(torch.arange(L), A_re.dtype)
        P = torch.exp(logdA[:, :, None] * l[None, None, :])
        K = torch.einsum("dn,dnl,dn->dl", Cc, P, dB).real
        L2 = 2 * L
        Kp = _pad(K, ((0, 0), (0, L)))
        up = (lambda x, *d: x.permute(*d))(u, 0, 2, 1)
        up = _pad(up, ((0, 0), (0, 0), (0, L)))
        Kf = (lambda x, axes=(-2,-1): torch.fft.rfft2(x.float(), dim=axes))(Kp[:, None, :], axes=(-2, -1))
        Uf = (lambda x, axes=(-2,-1): torch.fft.rfft2(x.float(), dim=axes))(up[:, :, None, :], axes=(-2, -1))
        Yf = Uf * Kf[None, :, :, :]
        y = (lambda x, s, axes=(-2,-1): torch.fft.irfft2(x, s=s, dim=axes).to(torch.bfloat16))(Yf, (1, L2), axes=(-2, -1))[:, :, 0, :L]
        y = (lambda x, *d: x.permute(*d))(y, 0, 2, 1) + u * Dskip[None, None, :]
        return y

    def _B_ref(x, wqkv, wo):
        B, S, D = x.shape
        H = 32; Dh = D // H
        qkv = (lambda x, *d: x.permute(*d))((x @ wqkv).reshape(B, S, 3, H, Dh), 2, 0, 3, 1, 4)
        q, k, v = qkv[0], qkv[1], qkv[2]
        phi = lambda t: torch.where(t > 0, t + 1, torch.exp(t)) + 1e-6
        pq, pk = phi(q), phi(k)
        kv = torch.einsum("bhsd,bhse->bhde", pk, v)
        z = torch.einsum("bhsd->bhd", pk)
        num = torch.einsum("bhqd,bhde->bhqe", pq, kv)
        den = torch.einsum("bhqd,bhd->bhq", pq, z)[..., None] + 1e-6
        o = num / den
        return (lambda x, *d: x.permute(*d))(o, 0, 2, 1, 3).reshape(B, S, D) @ wo

    x = A_u
    g = _sigmoid((x * gate_w).sum(-1, keepdims=True))
    a = _A_ref(x, A_A_re, A_A_im, A_B_re, A_B_im, A_C_re, A_C_im, A_log_dt, A_Dskip)
    b = _B_ref(x, B_wqkv, B_wo)
    return g * a + (1 - g) * b
```

```asm
; @launch grid=(512,1,1) block=(256,1,1) lds=81920
.amdgcn_target "amdgcn-amd-amdhsa--gfx950"
.text
.globl gated_mix__ssm_conv_s4__linear_attn_block__prompt_kernel
.p2align 8
.type gated_mix__ssm_conv_s4__linear_attn_block__prompt_kernel,@function
gated_mix__ssm_conv_s4__linear_attn_block__prompt_kernel:
    s_load_dwordx16 s[8:23], s[0:1], 0
    s_load_dwordx16 s[24:39], s[0:1], 64
    s_sub_u32 s3, s2, 192
    s_cmp_ge_u32 s3, 16
    s_cbranch_scc1 nocpf
    s_getpc_b64 s[44:45]
    s_and_b32 s3, s3, 8
    s_lshl_b32 s3, s3, 12
    v_lshl_add_u32 v3, v0, 7, s3
    s_and_b32 s44, s44, 0xffffff00
    v_min_u32 v3, X_exit-gated_mix__ssm_conv_s4__linear_attn_block__prompt_kernel, v3
    global_load_dword v128, v3, s[44:45]
nocpf:
    v_and_b32 v1, 63, v0
    v_lshrrev_b32 v2, 6, v0
    s_nop 0
    v_readfirstlane_b32 s40, v2
    s_and_b32 s6, s2, 7
    s_lshr_b32 s7, s2, 3
    s_cmp_lt_u32 s2, 256
    s_cbranch_scc1 notA
    s_setprio 3
    s_cmp_ge_u32 s2, 512
    s_cbranch_scc1 X_exit
    s_lshr_b32 s60, s40, 1
    s_add_u32 s60, s60, 1
    s_and_b32 s43, s40, 1
    s_lshl_b32 s42, s2, 1
    s_sub_u32 s42, s42, 256
    s_add_u32 s42, s42, s43
    s_lshl_b32 s43, s2, 2
    s_sub_u32 s43, s43, 1792
    s_add_u32 s43, s43, s40
    s_cmp_ge_u32 s2, 448
    s_cselect_b32 s60, 0, s60
    s_cselect_b32 s41, s43, s42
    s_mul_i32 s42, s41, 384
    v_lshl_add_u32 v2, v1, 2, s42
    v_lshl_add_u32 v3, v1, 1, s42
    s_lshl_b32 s42, s41, 1
    s_and_b32 s42, s42, 0xfffffffc
    s_cmp_ge_u32 s2, 448
    s_cselect_b32 s43, 192, 0
    s_sub_u32 s43, s2, s43
    s_lshl_b32 s43, s43, 8
    s_add_u32 s43, s43, 6750208
    v_mov_b32 v175, s43
    s_waitcnt lgkmcnt(0)
    s_cmp_eq_u32 s60, 2
    s_cbranch_scc1 A_h2
    global_load_dword v162, v2, s[10:11] nt
    global_load_dword v163, v2, s[12:13] nt
    global_load_dword v164, v2, s[14:15] nt
    global_load_dword v165, v2, s[16:17] nt
    global_load_dword v166, v2, s[18:19] nt
    global_load_dword v167, v2, s[20:21] nt
    s_cmp_eq_u32 s60, 1
    s_cbranch_scc1 A_h3
A_h2:
    global_load_ushort v168, v3, s[10:11] offset:256 nt
    global_load_ushort v169, v3, s[12:13] offset:256 nt
    global_load_ushort v170, v3, s[14:15] offset:256 nt
    global_load_ushort v171, v3, s[16:17] offset:256 nt
    global_load_ushort v172, v3, s[18:19] offset:256 nt
    global_load_ushort v173, v3, s[20:21] offset:256 nt
    global_load_dword v174, v175, s[38:39] sc1
A_h3:
    s_load_dword s64, s[22:23], s42
    s_load_dword s65, s[24:25], s42
    s_setprio 0
    s_branch A_body
notA:
    s_cmp_lt_u32 s2, 192
    s_cbranch_scc1 isG
    s_setprio 2
    s_sub_u32 s5, s2, 192
    s_cmp_eq_u32 s40, 3
    s_cbranch_scc1 notG
    v_lshrrev_b32 v2, 3, v1
    v_and_b32 v3, 7, v1
    v_mul_u32_u24 v4, 10240, v2
    v_lshl_add_u32 v4, v3, 4, v4
    v_add_u32 v5, 5120, v4
    s_and_b32 s41, s6, 3
    s_lshl_b32 s41, s41, 3
    s_lshr_b32 s54, s5, 3
    s_add_u32 s41, s41, s54
    s_lshr_b32 s42, s6, 2
    s_lshl_b32 s43, s40, 1
    s_add_u32 s53, s43, 6
    s_add_u32 s43, s43, s42
    s_sub_u32 s53, s53, s42
    s_mul_i32 s44, s41, 81920
    s_min_u32 s45, s43, 4
    s_lshl_b32 s45, s45, 7
    s_add_u32 s45, s44, s45
    s_waitcnt lgkmcnt(0)
    s_add_u32 s48, s8, s45
    s_addc_u32 s49, s9, 0
    global_load_dwordx4 v[16:19], v4, s[48:49] offset:0
    global_load_dwordx4 v[20:23], v4, s[48:49] offset:1280
    global_load_dwordx4 v[24:27], v4, s[48:49] offset:2560
    global_load_dwordx4 v[28:31], v4, s[48:49] offset:3840
    global_load_dwordx4 v[32:35], v5, s[48:49] offset:0
    global_load_dwordx4 v[36:39], v5, s[48:49] offset:1280
    global_load_dwordx4 v[40:43], v5, s[48:49] offset:2560
    global_load_dwordx4 v[44:47], v5, s[48:49] offset:3840
    s_branch T_tr2
isG:
    s_cmp_ge_u32 s2, 128
    s_cselect_b32 s63, 1, 0
    s_and_b32 s41, s7, 3
    s_and_b32 s3, s6, 3
    s_lshl_b32 s3, s3, 2
    s_add_u32 s3, s3, s41
    s_lshr_b32 s42, s7, 2
    s_lshr_b32 s43, s6, 2
    s_sub_u32 s44, 2, s63
    s_lshl_b32 s43, s43, s44
    s_and_b32 s4, s42, 3
    s_add_u32 s4, s4, s43
    s_add_u32 s5, s42, s41
    s_and_b32 s41, s6, 3
    s_add_u32 s5, s5, s41
    s_lshr_b32 s41, s6, 2
    s_lshl_b32 s41, s41, 1
    s_add_u32 s5, s5, s41
    s_mul_i32 s41, s5, 52
    s_lshr_b32 s41, s41, 8
    s_mul_i32 s41, s41, 5
    s_sub_u32 s41, s5, s41
    s_lshl_b32 s41, s41, 2
    s_mov_b32 s64, 0x21043210
    s_mov_b32 s65, 0x3
    s_lshr_b64 s[64:65], s[64:65], s41
    s_and_b32 s64, s64, 0xfffff
    s_and_b32 s41, s7, 3
    s_sub_u32 s5, s5, s41
    s_add_u32 s41, s41, 1
    s_and_b32 s41, s41, 3
    s_add_u32 s5, s5, s41
    s_mul_i32 s41, s5, 52
    s_lshr_b32 s41, s41, 8
    s_mul_i32 s41, s41, 5
    s_sub_u32 s41, s5, s41
    s_lshl_b32 s41, s41, 2
    s_mov_b32 s60, 0x76598765
    s_mov_b32 s61, 0x8
    s_lshr_b64 s[60:61], s[60:61], s41
    s_and_b32 s60, s60, 0xfffff
    s_lshr_b32 s65, s60, 12
    s_lshl_b32 s60, s60, 20
    s_or_b32 s64, s64, s60
    s_setprio 2
    v_lshrrev_b32 v3, 3, v1
    v_and_b32 v4, 7, v1
    v_lshrrev_b32 v5, 4, v1
    v_xor_b32 v4, v4, v5
    v_mul_u32_u24 v3, 1280, v3
    v_lshl_add_u32 v6, v4, 4, v3
    s_and_b32 s57, s40, 1
    s_lshr_b32 s56, s40, 1
    s_lshl_b32 s41, s57, 6
    s_mul_i32 s58, s57, 10240
    v_xor_b32 v6, s41, v6
    s_mov_b32 s42, 0
    s_xor_b32 s42, s42, s56
    s_mul_i32 s41, s3, 163840
    s_add_u32 s41, s41, s58
    s_xor_b32 s58, s42, 0
    s_mul_i32 s58, s58, 20480
    s_add_u32 s58, s58, s41
    v_add_u32 v8, s58, v6
    s_xor_b32 s58, s42, 2
    s_mul_i32 s58, s58, 20480
    s_add_u32 s58, s58, s41
    v_add_u32 v9, s58, v6
    s_xor_b32 s58, s42, 4
    s_mul_i32 s58, s58, 20480
    s_add_u32 s58, s58, s41
    v_add_u32 v10, s58, v6
    s_xor_b32 s58, s42, 6
    s_mul_i32 s58, s58, 20480
    s_add_u32 s58, s58, s41
    v_add_u32 v11, s58, v6
    s_lshl_b32 s46, s40, 10
    s_add_u32 s47, s46, 32768
    s_mov_b64 s[60:61], s[64:65]
    s_and_b32 s44, s64, 15
    s_lshr_b64 s[64:65], s[64:65], 4
    s_lshl_b32 s43, s44, 7
    s_mul_i32 s44, s44, 245760
    s_waitcnt lgkmcnt(0)
    s_mov_b32 s48, s8
    s_and_b32 s49, s9, 0xffff
    s_mov_b32 s50, 2621440
    s_mov_b32 s51, 0x20000
    s_cmp_eq_u32 s63, 1
    s_cbranch_scc1 G_nx
    s_add_u32 m0, s46, 0
    s_nop 0
    buffer_load_dwordx4 v8, s[48:51], s43 offen lds
    s_add_u32 m0, s46, 4096
    s_nop 0
    buffer_load_dwordx4 v9, s[48:51], s43 offen lds
    s_add_u32 m0, s46, 8192
    s_nop 0
    buffer_load_dwordx4 v10, s[48:51], s43 offen lds
    s_add_u32 m0, s46, 12288
    s_nop 0
    buffer_load_dwordx4 v11, s[48:51], s43 offen lds
G_nx:
    s_mov_b32 s52, s28
    s_and_b32 s53, s29, 0xffff
    s_mov_b32 s54, 2457600
    s_mov_b32 s55, 0x20000
    s_cmp_eq_u32 s63, 1
    s_cselect_b32 s59, 0, 1280
    s_cselect_b32 s62, 0, 1120
    s_lshl_b32 s58, 160, s63
    s_mul_i32 s58, s58, s4
    s_add_u32 s58, s58, s59
    v_mov_b32 v7, s62
    v_mul_u32_u24 v4, 3277, v0
    v_lshrrev_b32 v4, 16, v4
    v_mul_u32_u24 v5, 20, v4
    v_sub_u32 v3, v0, v5
    v_lshrrev_b32 v5, 2, v4
    v_and_b32 v5, 2, v5
    v_xor_b32 v3, v3, v5
    v_cmp_lt_u32 vcc, 9, v3
    v_mul_u32_u24 v4, 3840, v4
    v_lshl_add_u32 v4, v3, 4, v4
    v_cndmask_b32 v5, 0, v7, vcc
    v_add3_u32 v12, v4, v5, s58
    s_cmp_eq_u32 s63, 1
    s_cbranch_scc1 G_nw0
    s_add_u32 m0, s47, 0
    s_nop 0
    buffer_load_dwordx4 v12, s[52:55], s44 offen lds
G_nw0:
    v_add_u32 v3, 256, v0
    v_mul_u32_u24 v4, 3277, v3
    v_lshrrev_b32 v4, 16, v4
    v_mul_u32_u24 v5, 20, v4
    v_sub_u32 v3, v3, v5
    v_lshrrev_b32 v5, 2, v4
    v_and_b32 v5, 2, v5
    v_xor_b32 v3, v3, v5
    v_cmp_lt_u32 vcc, 9, v3
    v_mul_u32_u24 v4, 3840, v4
    v_lshl_add_u32 v4, v3, 4, v4
    v_cndmask_b32 v5, 0, v7, vcc
    v_add3_u32 v13, v4, v5, s58
    s_cmp_eq_u32 s63, 1
    s_cbranch_scc1 G_nw1
    s_add_u32 m0, s47, 4096
    s_nop 0
    buffer_load_dwordx4 v13, s[52:55], s44 offen lds
G_nw1:
    v_add_u32 v3, 512, v0
    v_mul_u32_u24 v4, 3277, v3
    v_lshrrev_b32 v4, 16, v4
    v_mul_u32_u24 v5, 20, v4
    v_sub_u32 v3, v3, v5
    v_lshrrev_b32 v5, 2, v4
    v_and_b32 v5, 2, v5
    v_xor_b32 v3, v3, v5
    v_cmp_lt_u32 vcc, 9, v3
    v_mul_u32_u24 v4, 3840, v4
    v_lshl_add_u32 v4, v3, 4, v4
    v_cndmask_b32 v5, 0, v7, vcc
    v_add3_u32 v14, v4, v5, s58
    s_cmp_eq_u32 s63, 1
    s_cbranch_scc1 G_nw2
    s_add_u32 m0, s47, 8192
    s_nop 0
    buffer_load_dwordx4 v14, s[52:55], s44 offen lds
G_nw2:
    v_add_u32 v3, 768, v0
    v_mul_u32_u24 v4, 3277, v3
    v_lshrrev_b32 v4, 16, v4
    v_mul_u32_u24 v5, 20, v4
    v_sub_u32 v3, v3, v5
    v_lshrrev_b32 v5, 2, v4
    v_and_b32 v5, 2, v5
    v_xor_b32 v3, v3, v5
    v_cmp_lt_u32 vcc, 9, v3
    v_mul_u32_u24 v4, 3840, v4
    v_lshl_add_u32 v4, v3, 4, v4
    v_cndmask_b32 v5, 0, v7, vcc
    v_add3_u32 v15, v4, v5, s58
    s_cmp_eq_u32 s63, 1
    s_cbranch_scc1 G_nw3
    s_add_u32 m0, s47, 12288
    s_nop 0
    buffer_load_dwordx4 v15, s[52:55], s44 offen lds
G_nw3:
    v_add_u32 v3, 1024, v0
    v_mul_u32_u24 v4, 3277, v3
    v_lshrrev_b32 v4, 16, v4
    v_mul_u32_u24 v5, 20, v4
    v_sub_u32 v3, v3, v5
    v_lshrrev_b32 v5, 2, v4
    v_and_b32 v5, 2, v5
    v_xor_b32 v3, v3, v5
    v_cmp_lt_u32 vcc, 9, v3
    v_mul_u32_u24 v4, 3840, v4
    v_lshl_add_u32 v4, v3, 4, v4
    v_cndmask_b32 v5, 0, v7, vcc
    v_add3_u32 v16, v4, v5, s58
    s_cmp_eq_u32 s63, 1
    s_cbranch_scc1 G_nw4
    s_add_u32 m0, s47, 16384
    s_nop 0
    buffer_load_dwordx4 v16, s[52:55], s44 offen lds
G_nw4:
    s_cmp_eq_u32 s63, 1
    s_cbranch_scc1 Q_comp
    v_and_b32 v42, 15, v1
    v_lshrrev_b32 v43, 4, v1
    v_lshrrev_b32 v44, 1, v42
    v_xor_b32 v44, v44, v43
    v_lshlrev_b32 v45, 7, v42
    s_lshl_b32 s41, s56, 13
    v_add_u32 v45, s41, v45
    v_lshl_add_u32 v2, v44, 4, v45
    v_xor_b32 v3, 64, v2
    v_lshrrev_b32 v44, 2, v42
    v_and_b32 v45, 3, v42
    v_lshl_add_u32 v44, v43, 3, v44
    v_mul_u32_u24 v44, 320, v44
    v_add_u32 v44, 32768, v44
    v_and_b32 v46, 1, v43
    v_lshlrev_b32 v46, 5, v46
    s_mul_i32 s41, s57, 80
    s_add_u32 s42, s41, 0
    v_lshl_add_u32 v47, v45, 3, s42
    v_xor_b32 v47, v47, v46
    v_add_u32 v17, v47, v44
    s_add_u32 s42, s41, 40
    v_lshl_add_u32 v47, v45, 3, s42
    v_xor_b32 v47, v47, v46
    v_add_u32 v18, v47, v44
    s_add_u32 s42, s41, 160
    v_lshl_add_u32 v47, v45, 3, s42
    v_xor_b32 v47, v47, v46
    v_add_u32 v19, v47, v44
    s_add_u32 s42, s41, 200
    v_lshl_add_u32 v47, v45, 3, s42
    v_xor_b32 v47, v47, v46
    v_add_u32 v20, v47, v44
    s_add_u32 s42, s41, 32
    v_mul_u32_u24 v47, 40, v45
    v_lshrrev_b32 v48, 1, v45
    v_mul_u32_u24 v48, 80, v48
    v_add_u32 v47, v47, v48
    v_add_u32 v47, s42, v47
    v_xor_b32 v47, v47, v46
    v_add_u32 v21, v47, v44
    v_mov_b32 v4, 0
    v_mov_b32 v5, 0
    v_mov_b32 v140, v4
    v_mov_b32 v141, v4
    v_mov_b32 v142, v4
    v_mov_b32 v143, v4
    v_mov_b32 v144, v4
    v_mov_b32 v145, v4
    v_mov_b32 v146, v4
    v_mov_b32 v147, v4
    v_mov_b32 v148, v4
    v_mov_b32 v149, v4
    v_mov_b32 v150, v4
    v_mov_b32 v151, v4
    v_mov_b32 v152, v4
    v_mov_b32 v153, v4
    v_mov_b32 v154, v4
    v_mov_b32 v155, v4
    v_mov_b32 v156, v4
    v_mov_b32 v157, v4
    v_mov_b32 v158, v4
    v_mov_b32 v159, v4
    v_mov_b32 v160, v4
    v_mov_b32 v161, v4
    v_mov_b32 v162, v4
    v_mov_b32 v163, v4
    v_mov_b32 v164, v4
    v_mov_b32 v165, v4
    v_mov_b32 v166, v4
    v_mov_b32 v167, v4
    v_mov_b32 v168, v4
    v_mov_b32 v169, v4
    v_mov_b32 v170, v4
    v_mov_b32 v171, v4
    v_mov_b32 v172, v4
    v_mov_b32 v173, v4
    v_mov_b32 v174, v4
    v_mov_b32 v175, v4
    v_mov_b32 v176, v4
    v_mov_b32 v177, v4
    v_mov_b32 v178, v4
    v_mov_b32 v179, v4
    v_mov_b32 v180, v4
    v_mov_b32 v181, v4
    v_mov_b32 v182, v4
    v_mov_b32 v183, v4
    v_mov_b32 v184, v4
    v_mov_b32 v185, v4
    v_mov_b32 v186, v4
    v_mov_b32 v187, v4
    v_mov_b32 v188, v4
    v_mov_b32 v189, v4
    v_mov_b32 v190, v4
    v_mov_b32 v191, v4
    v_mov_b32 v192, v4
    v_mov_b32 v193, v4
    v_mov_b32 v194, v4
    v_mov_b32 v195, v4
    v_mov_b32 v196, v4
    v_mov_b32 v197, v4
    v_mov_b32 v198, v4
    v_mov_b32 v199, v4
    v_mov_b32 v200, v4
    v_mov_b32 v201, v4
    v_mov_b32 v202, v4
    v_mov_b32 v203, v4
    v_mov_b32 v204, v4
    v_mov_b32 v205, v4
    v_mov_b32 v206, v4
    v_mov_b32 v207, v4
    v_mov_b32 v208, v4
    v_mov_b32 v209, v4
    v_mov_b32 v210, v4
    v_mov_b32 v211, v4
    v_mov_b32 v212, v4
    v_mov_b32 v213, v4
    v_mov_b32 v214, v4
    v_mov_b32 v215, v4
    v_mov_b32 v216, v4
    v_mov_b32 v217, v4
    v_mov_b32 v218, v4
    v_mov_b32 v219, v4
    s_mov_b32 s24, s2
    s_mov_b32 s25, 0
    s_mov_b32 s10, 0
    s_and_b32 s20, s2, 7
    s_lshr_b32 s21, s2, 3
    s_mul_i32 s22, s21, 52
    s_lshr_b32 s22, s22, 8
    s_lshl_b32 s16, s20, 2
    s_add_u32 s16, s16, s22
    s_mul_i32 s22, s22, 5
    s_sub_u32 s17, s21, s22
    s_and_b32 s18, s17, 3
    s_mov_b32 s11, 0
    s_lshl_b32 s19, s40, 10
    s_mov_b32 s12, s30
    s_and_b32 s13, s31, 0xffff
    s_mov_b32 s14, 819200
    s_mov_b32 s15, 0x20000
    v_lshrrev_b32 v220, 4, v0
    v_and_b32 v221, 15, v0
    v_and_b32 v222, 3, v220
    v_lshlrev_b32 v222, 2, v222
    v_xor_b32 v221, v221, v222
    v_mul_u32_u24 v220, 1280, v220
    v_lshl_add_u32 v220, v221, 4, v220
    s_lshl_b32 s20, s17, 8
    v_add_u32 v220, s20, v220
    s_xor_b32 s20, s18, 0
    s_mul_i32 s26, s20, 204800
    s_xor_b32 s20, s18, 1
    s_mul_i32 s27, s20, 204800
    s_xor_b32 s20, s18, 2
    s_mul_i32 s28, s20, 204800
    s_xor_b32 s20, s18, 3
    s_mul_i32 s29, s20, 204800
    v_bfe_u32 v236, v1, 2, 2
    v_lshrrev_b32 v237, 5, v1
    v_and_b32 v234, 1, v1
    v_bfe_u32 v235, v1, 1, 1
    v_lshl_add_u32 v234, v234, 1, v235
    s_lshl_b32 s20, s40, 6
    v_lshl_add_u32 v234, v234, 3, s20
    v_bfe_u32 v235, v1, 4, 1
    v_lshl_add_u32 v234, v235, 5, v234
    v_lshlrev_b32 v235, 6, v236
    v_xor_b32 v234, v234, v235
    v_lshl_add_u32 v234, v236, 8, v234
    v_mul_u32_u24 v235, 5120, v237
    v_add_u32 v235, 4096, v235
    v_add_u32 v235, v235, v234
    v_lshl_add_u32 v234, v237, 10, v234
    v_add_u32 v236, 40960, v234
    v_add_u32 v237, 40960, v235
    s_mul_i32 s41, s56, 6912
    s_mul_i32 s42, s57, 3360
    s_add_u32 s41, s41, s42
    s_add_u32 s41, s41, 61440
    v_mul_u32_u24 v224, 80, v42
    v_add_u32 v224, s41, v224
    v_lshl_add_u32 v225, v43, 4, v224
    v_mul_u32_u24 v228, 1680, v43
    v_add_u32 v224, v224, v228
    v_and_b32 v226, 3, v42
    v_add_u32 v226, 16, v226
    v_cmp_eq_u32 vcc, 0, v42
    v_mov_b32 v227, 20
    s_nop 0
    v_cndmask_b32 v226, v226, v227, vcc
    v_mul_u32_u24 v226, 80, v226
    v_add_u32 v226, s41, v226
    v_lshl_add_u32 v227, v43, 4, v226
    v_add_u32 v228, v228, v226
    v_lshlrev_b32 v229, 2, v0
    s_mul_i32 s41, s4, 6784
    s_add_u32 s41, s41, 6356992
    v_add_u32 v230, s41, v229
    v_add_u32 v231, 4096, v230
    v_add_u32 v229, 61440, v229
    v_mov_b32 v232, 0x3f803f80
    s_mov_b32 s22, 0xffff0000
    s_mov_b32 s23, 0
    s_lshl_b32 s60, s2, 8
    s_add_u32 s60, s60, 6815744
    v_mov_b32 v4, s60
    v_mov_b32 v5, 1
    v_mov_b32 v6, 0
    s_mov_b32 s60, 0x3fb8aa3b
    s_mov_b32 s61, 0x3fb8aa3b
    s_mov_b32 s62, 0x358637bd
    s_and_b32 s44, s64, 15
    s_lshr_b64 s[64:65], s[64:65], 4
    s_lshl_b32 s43, s44, 7
    s_mul_i32 s44, s44, 245760
    s_add_u32 m0, s46, 16384
    s_nop 0
    buffer_load_dwordx4 v8, s[48:51], s43 offen lds
    s_add_u32 m0, s47, 20480
    s_nop 0
    buffer_load_dwordx4 v12, s[52:55], s44 offen lds
    s_add_u32 m0, s46, 20480
    s_nop 0
    buffer_load_dwordx4 v9, s[48:51], s43 offen lds
    s_add_u32 m0, s47, 24576
    s_nop 0
    buffer_load_dwordx4 v13, s[52:55], s44 offen lds
    s_add_u32 m0, s46, 24576
    s_nop 0
    buffer_load_dwordx4 v10, s[48:51], s43 offen lds
    s_add_u32 m0, s47, 28672
    s_nop 0
    buffer_load_dwordx4 v14, s[52:55], s44 offen lds
    s_add_u32 m0, s46, 28672
    s_nop 0
    buffer_load_dwordx4 v11, s[48:51], s43 offen lds
    s_add_u32 m0, s47, 32768
    s_nop 0
    buffer_load_dwordx4 v15, s[52:55], s44 offen lds
    s_add_u32 m0, s47, 36864
    s_nop 0
    buffer_load_dwordx4 v16, s[52:55], s44 offen lds
    s_and_b32 s44, s64, 15
    s_lshr_b64 s[64:65], s[64:65], 4
    s_lshl_b32 s43, s44, 7
    s_mul_i32 s44, s44, 245760
    s_waitcnt vmcnt(11) lgkmcnt(0)
    s_barrier
    ds_read_b128 v[76:79], v2 offset:0
    ds_read_b128 v[80:83], v2 offset:2048
    ds_read_b128 v[84:87], v2 offset:4096
    ds_read_b128 v[88:91], v2 offset:6144
    ds_read_b64_tr_b16 v[52:53], v21 offset:0
    ds_read_b64_tr_b16 v[54:55], v21 offset:1280
    ds_read_b64_tr_b16 v[44:45], v19 offset:0
    ds_read_b64_tr_b16 v[46:47], v19 offset:1280
    ds_read_b64_tr_b16 v[48:49], v20 offset:0
    ds_read_b64_tr_b16 v[50:51], v20 offset:1280
    ds_read_b64_tr_b16 v[36:37], v17 offset:0
    ds_read_b64_tr_b16 v[38:39], v17 offset:1280
    ds_read_b64_tr_b16 v[40:41], v18 offset:0
    ds_read_b64_tr_b16 v[42:43], v18 offset:1280
    ds_read_b128 v[92:95], v3 offset:0
    ds_read_b128 v[96:99], v3 offset:2048
    ds_read_b128 v[100:103], v3 offset:4096
    ds_read_b128 v[104:107], v3 offset:6144
    s_mov_b32 s45, 4
.p2align 3
KV_loop:
    s_waitcnt lgkmcnt(12)
    v_mfma_f32_16x16x32_bf16 v[156:159], v[76:79], v[52:55], v[156:159]
    v_mfma_f32_16x16x32_bf16 v[176:179], v[80:83], v[52:55], v[176:179]
    v_mfma_f32_16x16x32_bf16 v[196:199], v[84:87], v[52:55], v[196:199]
    v_mfma_f32_16x16x32_bf16 v[216:219], v[88:91], v[52:55], v[216:219]
    s_waitcnt vmcnt(9) lgkmcnt(0)
    s_barrier
    v_mfma_f32_16x16x32_bf16 v[148:151], v[76:79], v[44:47], v[148:151]
    ds_read_b64_tr_b16 v[72:73], v21 offset:10240
    s_add_u32 m0, s46, 0
    v_mfma_f32_16x16x32_bf16 v[168:171], v[80:83], v[44:47], v[168:171]
    buffer_load_dwordx4 v8, s[48:51], s43 offen lds
    ds_read_b64_tr_b16 v[74:75], v21 offset:11520
    v_mfma_f32_16x16x32_bf16 v[188:191], v[84:87], v[44:47], v[188:191]
    v_mfma_f32_16x16x32_bf16 v[208:211], v[88:91], v[44:47], v[208:211]
    ds_read_b64_tr_b16 v[64:65], v19 offset:10240
    s_add_u32 m0, s47, 0
    v_mfma_f32_16x16x32_bf16 v[152:155], v[76:79], v[48:51], v[152:155]
    buffer_load_dwordx4 v12, s[52:55], s44 offen lds
    ds_read_b64_tr_b16 v[66:67], v19 offset:11520
    v_mfma_f32_16x16x32_bf16 v[172:175], v[80:83], v[48:51], v[172:175]
    ds_read_b64_tr_b16 v[68:69], v20 offset:10240
    v_mfma_f32_16x16x32_bf16 v[192:195], v[84:87], v[48:51], v[192:195]
    s_add_u32 m0, s46, 4096
    v_mfma_f32_16x16x32_bf16 v[212:215], v[88:91], v[48:51], v[212:215]
    buffer_load_dwordx4 v9, s[48:51], s43 offen lds
    ds_read_b64_tr_b16 v[70:71], v20 offset:11520
    v_mfma_f32_16x16x32_bf16 v[140:143], v[76:79], v[36:39], v[140:143]
    ds_read_b64_tr_b16 v[56:57], v17 offset:10240
    v_mfma_f32_16x16x32_bf16 v[160:163], v[80:83], v[36:39], v[160:163]
    s_add_u32 m0, s47, 4096
    v_mfma_f32_16x16x32_bf16 v[180:183], v[84:87], v[36:39], v[180:183]
    buffer_load_dwordx4 v13, s[52:55], s44 offen lds
    ds_read_b64_tr_b16 v[58:59], v17 offset:11520
    v_mfma_f32_16x16x32_bf16 v[200:203], v[88:91], v[36:39], v[200:203]
    ds_read_b64_tr_b16 v[60:61], v18 offset:10240
    v_mfma_f32_16x16x32_bf16 v[144:147], v[76:79], v[40:43], v[144:147]
    ds_read_b64_tr_b16 v[62:63], v18 offset:11520
    s_add_u32 m0, s46, 8192
    v_mfma_f32_16x16x32_bf16 v[164:167], v[80:83], v[40:43], v[164:167]
    buffer_load_dwordx4 v10, s[48:51], s43 offen lds
    v_mfma_f32_16x16x32_bf16 v[184:187], v[84:87], v[40:43], v[184:187]
    v_mfma_f32_16x16x32_bf16 v[204:207], v[88:91], v[40:43], v[204:207]
    s_waitcnt lgkmcnt(8)
    v_mfma_f32_16x16x32_bf16 v[156:159], v[92:95], v[72:75], v[156:159]
    v_mfma_f32_16x16x32_bf16 v[176:179], v[96:99], v[72:75], v[176:179]
    v_mfma_f32_16x16x32_bf16 v[196:199], v[100:103], v[72:75], v[196:199]
    v_mfma_f32_16x16x32_bf16 v[216:219], v[104:107], v[72:75], v[216:219]
    s_waitcnt vmcnt(7) lgkmcnt(0)
    s_barrier
    ds_read_b128 v[108:111], v2 offset:16384
    v_mfma_f32_16x16x32_bf16 v[148:151], v[92:95], v[64:67], v[148:151]
    ds_read_b128 v[112:115], v2 offset:18432
    s_add_u32 m0, s47, 8192
    v_mfma_f32_16x16x32_bf16 v[168:171], v[96:99], v[64:67], v[168:171]
    buffer_load_dwordx4 v14, s[52:55], s44 offen lds
    ds_read_b128 v[116:119], v2 offset:20480
    v_mfma_f32_16x16x32_bf16 v[188:191], v[100:103], v[64:67], v[188:191]
    ds_read_b128 v[120:123], v2 offset:22528
    ds_read_b64_tr_b16 v[52:53], v21 offset:20480
    v_mfma_f32_16x16x32_bf16 v[208:211], v[104:107], v[64:67], v[208:211]
    ds_read_b64_tr_b16 v[54:55], v21 offset:21760
    v_mfma_f32_16x16x32_bf16 v[152:155], v[92:95], v[68:71], v[152:155]
    ds_read_b64_tr_b16 v[44:45], v19 offset:20480
    s_add_u32 m0, s46, 12288
    v_mfma_f32_16x16x32_bf16 v[172:175], v[96:99], v[68:71], v[172:175]
    buffer_load_dwordx4 v11, s[48:51], s43 offen lds
    ds_read_b64_tr_b16 v[46:47], v19 offset:21760
    ds_read_b64_tr_b16 v[48:49], v20 offset:20480
    v_mfma_f32_16x16x32_bf16 v[192:195], v[100:103], v[68:71], v[192:195]
    ds_read_b64_tr_b16 v[50:51], v20 offset:21760
    v_mfma_f32_16x16x32_bf16 v[212:215], v[104:107], v[68:71], v[212:215]
    ds_read_b64_tr_b16 v[36:37], v17 offset:20480
    v_mfma_f32_16x16x32_bf16 v[140:143], v[92:95], v[56:59], v[140:143]
    ds_read_b64_tr_b16 v[38:39], v17 offset:21760
    s_add_u32 m0, s47, 12288
    v_mfma_f32_16x16x32_bf16 v[160:163], v[96:99], v[56:59], v[160:163]
    buffer_load_dwordx4 v15, s[52:55], s44 offen lds
    ds_read_b64_tr_b16 v[40:41], v18 offset:20480
    ds_read_b64_tr_b16 v[42:43], v18 offset:21760
    v_mfma_f32_16x16x32_bf16 v[180:183], v[100:103], v[56:59], v[180:183]
    ds_read_b128 v[124:127], v3 offset:16384
    v_mfma_f32_16x16x32_bf16 v[200:203], v[104:107], v[56:59], v[200:203]
    ds_read_b128 v[128:131], v3 offset:18432
    v_mfma_f32_16x16x32_bf16 v[144:147], v[92:95], v[60:63], v[144:147]
    ds_read_b128 v[132:135], v3 offset:20480
    ds_read_b128 v[136:139], v3 offset:22528
    s_add_u32 m0, s47, 16384
    v_mfma_f32_16x16x32_bf16 v[164:167], v[96:99], v[60:63], v[164:167]
    buffer_load_dwordx4 v16, s[52:55], s44 offen lds
    s_and_b32 s44, s64, 15
    s_lshr_b64 s[64:65], s[64:65], 4
    s_lshl_b32 s43, s44, 7
    s_mul_i32 s44, s44, 245760
    v_mfma_f32_16x16x32_bf16 v[184:187], v[100:103], v[60:63], v[184:187]
    v_mfma_f32_16x16x32_bf16 v[204:207], v[104:107], v[60:63], v[204:207]
KV_mid:
    s_waitcnt lgkmcnt(12)
    v_mfma_f32_16x16x32_bf16 v[156:159], v[108:111], v[52:55], v[156:159]
    v_mfma_f32_16x16x32_bf16 v[176:179], v[112:115], v[52:55], v[176:179]
    v_mfma_f32_16x16x32_bf16 v[196:199], v[116:119], v[52:55], v[196:199]
    v_mfma_f32_16x16x32_bf16 v[216:219], v[120:123], v[52:55], v[216:219]
    s_waitcnt vmcnt(9) lgkmcnt(0)
    s_barrier
    v_mfma_f32_16x16x32_bf16 v[148:151], v[108:111], v[44:47], v[148:151]
    ds_read_b64_tr_b16 v[72:73], v21 offset:30720
    s_add_u32 m0, s46, 16384
    v_mfma_f32_16x16x32_bf16 v[168:171], v[112:115], v[44:47], v[168:171]
    buffer_load_dwordx4 v8, s[48:51], s43 offen lds
    ds_read_b64_tr_b16 v[74:75], v21 offset:32000
    v_mfma_f32_16x16x32_bf16 v[188:191], v[116:119], v[44:47], v[188:191]
    v_mfma_f32_16x16x32_bf16 v[208:211], v[120:123], v[44:47], v[208:211]
    ds_read_b64_tr_b16 v[64:65], v19 offset:30720
    s_add_u32 m0, s47, 20480
    v_mfma_f32_16x16x32_bf16 v[152:155], v[108:111], v[48:51], v[152:155]
    buffer_load_dwordx4 v12, s[52:55], s44 offen lds
    ds_read_b64_tr_b16 v[66:67], v19 offset:32000
    v_mfma_f32_16x16x32_bf16 v[172:175], v[112:115], v[48:51], v[172:175]
    ds_read_b64_tr_b16 v[68:69], v20 offset:30720
    v_mfma_f32_16x16x32_bf16 v[192:195], v[116:119], v[48:51], v[192:195]
    s_add_u32 m0, s46, 20480
    v_mfma_f32_16x16x32_bf16 v[212:215], v[120:123], v[48:51], v[212:215]
    buffer_load_dwordx4 v9, s[48:51], s43 offen lds
    ds_read_b64_tr_b16 v[70:71], v20 offset:32000
    v_mfma_f32_16x16x32_bf16 v[140:143], v[108:111], v[36:39], v[140:143]
    ds_read_b64_tr_b16 v[56:57], v17 offset:30720
    v_mfma_f32_16x16x32_bf16 v[160:163], v[112:115], v[36:39], v[160:163]
    s_add_u32 m0, s47, 24576
    v_mfma_f32_16x16x32_bf16 v[180:183], v[116:119], v[36:39], v[180:183]
    buffer_load_dwordx4 v13, s[52:55], s44 offen lds
    ds_read_b64_tr_b16 v[58:59], v17 offset:32000
    v_mfma_f32_16x16x32_bf16 v[200:203], v[120:123], v[36:39], v[200:203]
    ds_read_b64_tr_b16 v[60:61], v18 offset:30720
    v_mfma_f32_16x16x32_bf16 v[144:147], v[108:111], v[40:43], v[144:147]
    ds_read_b64_tr_b16 v[62:63], v18 offset:32000
    s_add_u32 m0, s46, 24576
    v_mfma_f32_16x16x32_bf16 v[164:167], v[112:115], v[40:43], v[164:167]
    buffer_load_dwordx4 v10, s[48:51], s43 offen lds
    v_mfma_f32_16x16x32_bf16 v[184:187], v[116:119], v[40:43], v[184:187]
    v_mfma_f32_16x16x32_bf16 v[204:207], v[120:123], v[40:43], v[204:207]
    s_waitcnt lgkmcnt(8)
    v_mfma_f32_16x16x32_bf16 v[156:159], v[124:127], v[72:75], v[156:159]
    v_mfma_f32_16x16x32_bf16 v[176:179], v[128:131], v[72:75], v[176:179]
    v_mfma_f32_16x16x32_bf16 v[196:199], v[132:135], v[72:75], v[196:199]
    v_mfma_f32_16x16x32_bf16 v[216:219], v[136:139], v[72:75], v[216:219]
    s_waitcnt vmcnt(7) lgkmcnt(0)
    s_barrier
    ds_read_b128 v[76:79], v2 offset:0
    v_mfma_f32_16x16x32_bf16 v[148:151], v[124:127], v[64:67], v[148:151]
    ds_read_b128 v[80:83], v2 offset:2048
    s_add_u32 m0, s47, 28672
    v_mfma_f32_16x16x32_bf16 v[168:171], v[128:131], v[64:67], v[168:171]
    buffer_load_dwordx4 v14, s[52:55], s44 offen lds
    ds_read_b128 v[84:87], v2 offset:4096
    v_mfma_f32_16x16x32_bf16 v[188:191], v[132:135], v[64:67], v[188:191]
    ds_read_b128 v[88:91], v2 offset:6144
    ds_read_b64_tr_b16 v[52:53], v21 offset:0
    v_mfma_f32_16x16x32_bf16 v[208:211], v[136:139], v[64:67], v[208:211]
    ds_read_b64_tr_b16 v[54:55], v21 offset:1280
    v_mfma_f32_16x16x32_bf16 v[152:155], v[124:127], v[68:71], v[152:155]
    ds_read_b64_tr_b16 v[44:45], v19 offset:0
    s_add_u32 m0, s46, 28672
    v_mfma_f32_16x16x32_bf16 v[172:175], v[128:131], v[68:71], v[172:175]
    buffer_load_dwordx4 v11, s[48:51], s43 offen lds
    ds_read_b64_tr_b16 v[46:47], v19 offset:1280
    ds_read_b64_tr_b16 v[48:49], v20 offset:0
    v_mfma_f32_16x16x32_bf16 v[192:195], v[132:135], v[68:71], v[192:195]
    ds_read_b64_tr_b16 v[50:51], v20 offset:1280
    v_mfma_f32_16x16x32_bf16 v[212:215], v[136:139], v[68:71], v[212:215]
    ds_read_b64_tr_b16 v[36:37], v17 offset:0
    v_mfma_f32_16x16x32_bf16 v[140:143], v[124:127], v[56:59], v[140:143]
    ds_read_b64_tr_b16 v[38:39], v17 offset:1280
    s_add_u32 m0, s47, 32768
    v_mfma_f32_16x16x32_bf16 v[160:163], v[128:131], v[56:59], v[160:163]
    buffer_load_dwordx4 v15, s[52:55], s44 offen lds
    ds_read_b64_tr_b16 v[40:41], v18 offset:0
    ds_read_b64_tr_b16 v[42:43], v18 offset:1280
    v_mfma_f32_16x16x32_bf16 v[180:183], v[132:135], v[56:59], v[180:183]
    ds_read_b128 v[92:95], v3 offset:0
    v_mfma_f32_16x16x32_bf16 v[200:203], v[136:139], v[56:59], v[200:203]
    ds_read_b128 v[96:99], v3 offset:2048
    v_mfma_f32_16x16x32_bf16 v[144:147], v[124:127], v[60:63], v[144:147]
    ds_read_b128 v[100:103], v3 offset:4096
    ds_read_b128 v[104:107], v3 offset:6144
    s_add_u32 m0, s47, 36864
    v_mfma_f32_16x16x32_bf16 v[164:167], v[128:131], v[60:63], v[164:167]
    buffer_load_dwordx4 v16, s[52:55], s44 offen lds
    s_and_b32 s44, s64, 15
    s_lshr_b64 s[64:65], s[64:65], 4
    s_lshl_b32 s43, s44, 7
    s_mul_i32 s44, s44, 245760
    v_mfma_f32_16x16x32_bf16 v[184:187], v[132:135], v[60:63], v[184:187]
    v_mfma_f32_16x16x32_bf16 v[204:207], v[136:139], v[60:63], v[204:207]
    s_sub_u32 s45, s45, 1
    s_cmp_lg_u32 s45, 0
    s_cbranch_scc1 KV_loop
    s_mov_b64 exec, 1
    global_atomic_add v4, v5, s[38:39] sc1
    s_mov_b64 exec, -1
    s_waitcnt lgkmcnt(12)
    v_mfma_f32_16x16x32_bf16 v[156:159], v[76:79], v[52:55], v[156:159]
    v_mfma_f32_16x16x32_bf16 v[176:179], v[80:83], v[52:55], v[176:179]
    v_mfma_f32_16x16x32_bf16 v[196:199], v[84:87], v[52:55], v[196:199]
    v_mfma_f32_16x16x32_bf16 v[216:219], v[88:91], v[52:55], v[216:219]
    s_waitcnt vmcnt(10) lgkmcnt(0)
    s_barrier
    v_mfma_f32_16x16x32_bf16 v[148:151], v[76:79], v[44:47], v[148:151]
    ds_read_b64_tr_b16 v[72:73], v21 offset:10240
    s_add_u32 m0, s19, 0
    v_mfma_f32_16x16x32_bf16 v[168:171], v[80:83], v[44:47], v[168:171]
    s_add_u32 s20, s26, 0
    buffer_load_dwordx4 v220, s[12:15], s20 offen lds
    ds_read_b64_tr_b16 v[74:75], v21 offset:11520
    v_mfma_f32_16x16x32_bf16 v[188:191], v[84:87], v[44:47], v[188:191]
    v_mfma_f32_16x16x32_bf16 v[208:211], v[88:91], v[44:47], v[208:211]
    ds_read_b64_tr_b16 v[64:65], v19 offset:10240
    v_mfma_f32_16x16x32_bf16 v[152:155], v[76:79], v[48:51], v[152:155]
    ds_read_b64_tr_b16 v[66:67], v19 offset:11520
    v_mfma_f32_16x16x32_bf16 v[172:175], v[80:83], v[48:51], v[172:175]
    ds_read_b64_tr_b16 v[68:69], v20 offset:10240
    v_mfma_f32_16x16x32_bf16 v[192:195], v[84:87], v[48:51], v[192:195]
    v_mfma_f32_16x16x32_bf16 v[212:215], v[88:91], v[48:51], v[212:215]
    ds_read_b64_tr_b16 v[70:71], v20 offset:11520
    v_mfma_f32_16x16x32_bf16 v[140:143], v[76:79], v[36:39], v[140:143]
    ds_read_b64_tr_b16 v[56:57], v17 offset:10240
    v_mfma_f32_16x16x32_bf16 v[160:163], v[80:83], v[36:39], v[160:163]
    v_mfma_f32_16x16x32_bf16 v[180:183], v[84:87], v[36:39], v[180:183]
    ds_read_b64_tr_b16 v[58:59], v17 offset:11520
    v_mfma_f32_16x16x32_bf16 v[200:203], v[88:91], v[36:39], v[200:203]
    ds_read_b64_tr_b16 v[60:61], v18 offset:10240
    v_mfma_f32_16x16x32_bf16 v[144:147], v[76:79], v[40:43], v[144:147]
    ds_read_b64_tr_b16 v[62:63], v18 offset:11520
    v_mfma_f32_16x16x32_bf16 v[164:167], v[80:83], v[40:43], v[164:167]
    v_mfma_f32_16x16x32_bf16 v[184:187], v[84:87], v[40:43], v[184:187]
    v_mfma_f32_16x16x32_bf16 v[204:207], v[88:91], v[40:43], v[204:207]
    s_waitcnt lgkmcnt(8)
    v_mfma_f32_16x16x32_bf16 v[156:159], v[92:95], v[72:75], v[156:159]
    v_mfma_f32_16x16x32_bf16 v[176:179], v[96:99], v[72:75], v[176:179]
    v_mfma_f32_16x16x32_bf16 v[196:199], v[100:103], v[72:75], v[196:199]
    v_mfma_f32_16x16x32_bf16 v[216:219], v[104:107], v[72:75], v[216:219]
    s_waitcnt vmcnt(4) lgkmcnt(0)
    s_barrier
    ds_read_b128 v[108:111], v2 offset:16384
    v_mfma_f32_16x16x32_bf16 v[148:151], v[92:95], v[64:67], v[148:151]
    ds_read_b128 v[112:115], v2 offset:18432
    s_add_u32 m0, s19, 4096
    v_mfma_f32_16x16x32_bf16 v[168:171], v[96:99], v[64:67], v[168:171]
    s_add_u32 s20, s26, 20480
    buffer_load_dwordx4 v220, s[12:15], s20 offen lds
    ds_read_b128 v[116:119], v2 offset:20480
    v_mfma_f32_16x16x32_bf16 v[188:191], v[100:103], v[64:67], v[188:191]
    ds_read_b128 v[120:123], v2 offset:22528
    ds_read_b64_tr_b16 v[52:53], v21 offset:20480
    v_mfma_f32_16x16x32_bf16 v[208:211], v[104:107], v[64:67], v[208:211]
    ds_read_b64_tr_b16 v[54:55], v21 offset:21760
    v_mfma_f32_16x16x32_bf16 v[152:155], v[92:95], v[68:71], v[152:155]
    ds_read_b64_tr_b16 v[44:45], v19 offset:20480
    v_mfma_f32_16x16x32_bf16 v[172:175], v[96:99], v[68:71], v[172:175]
    ds_read_b64_tr_b16 v[46:47], v19 offset:21760
    ds_read_b64_tr_b16 v[48:49], v20 offset:20480
    s_add_u32 m0, s19, 8192
    v_mfma_f32_16x16x32_bf16 v[192:195], v[100:103], v[68:71], v[192:195]
    s_add_u32 s20, s26, 40960
    buffer_load_dwordx4 v220, s[12:15], s20 offen lds
    ds_read_b64_tr_b16 v[50:51], v20 offset:21760
    v_mfma_f32_16x16x32_bf16 v[212:215], v[104:107], v[68:71], v[212:215]
    ds_read_b64_tr_b16 v[36:37], v17 offset:20480
    v_mfma_f32_16x16x32_bf16 v[140:143], v[92:95], v[56:59], v[140:143]
    ds_read_b64_tr_b16 v[38:39], v17 offset:21760
    v_mfma_f32_16x16x32_bf16 v[160:163], v[96:99], v[56:59], v[160:163]
    ds_read_b64_tr_b16 v[40:41], v18 offset:20480
    ds_read_b64_tr_b16 v[42:43], v18 offset:21760
    v_mfma_f32_16x16x32_bf16 v[180:183], v[100:103], v[56:59], v[180:183]
    ds_read_b128 v[124:127], v3 offset:16384
    s_add_u32 m0, s19, 12288
    v_mfma_f32_16x16x32_bf16 v[200:203], v[104:107], v[56:59], v[200:203]
    s_add_u32 s20, s26, 61440
    buffer_load_dwordx4 v220, s[12:15], s20 offen lds
    ds_read_b128 v[128:131], v3 offset:18432
    v_mfma_f32_16x16x32_bf16 v[144:147], v[92:95], v[60:63], v[144:147]
    ds_read_b128 v[132:135], v3 offset:20480
    ds_read_b128 v[136:139], v3 offset:22528
    v_mfma_f32_16x16x32_bf16 v[164:167], v[96:99], v[60:63], v[164:167]
    v_mfma_f32_16x16x32_bf16 v[184:187], v[100:103], v[60:63], v[184:187]
    v_mfma_f32_16x16x32_bf16 v[204:207], v[104:107], v[60:63], v[204:207]
    global_load_dword v7, v6, s[36:37] sc1
    s_waitcnt lgkmcnt(12)
    v_mfma_f32_16x16x32_bf16 v[156:159], v[108:111], v[52:55], v[156:159]
    v_mfma_f32_16x16x32_bf16 v[176:179], v[112:115], v[52:55], v[176:179]
    v_mfma_f32_16x16x32_bf16 v[196:199], v[116:119], v[52:55], v[196:199]
    v_mfma_f32_16x16x32_bf16 v[216:219], v[120:123], v[52:55], v[216:219]
    s_waitcnt vmcnt(6) lgkmcnt(0)
    s_barrier
    v_mfma_f32_16x16x32_bf16 v[148:151], v[108:111], v[44:47], v[148:151]
    ds_read_b64_tr_b16 v[72:73], v21 offset:30720
    s_add_u32 m0, s19, 32768
    v_mfma_f32_16x16x32_bf16 v[168:171], v[112:115], v[44:47], v[168:171]
    s_add_u32 s20, s26, 163840
    buffer_load_dwordx4 v220, s[12:15], s20 offen lds
    ds_read_b64_tr_b16 v[74:75], v21 offset:32000
    v_mfma_f32_16x16x32_bf16 v[188:191], v[116:119], v[44:47], v[188:191]
    v_mfma_f32_16x16x32_bf16 v[208:211], v[120:123], v[44:47], v[208:211]
    ds_read_b64_tr_b16 v[64:65], v19 offset:30720
    v_mfma_f32_16x16x32_bf16 v[152:155], v[108:111], v[48:51], v[152:155]
    ds_read_b64_tr_b16 v[66:67], v19 offset:32000
    v_mfma_f32_16x16x32_bf16 v[172:175], v[112:115], v[48:51], v[172:175]
    ds_read_b64_tr_b16 v[68:69], v20 offset:30720
    s_add_u32 m0, s19, 36864
    v_mfma_f32_16x16x32_bf16 v[192:195], v[116:119], v[48:51], v[192:195]
    s_add_u32 s20, s26, 184320
    buffer_load_dwordx4 v220, s[12:15], s20 offen lds
    v_mfma_f32_16x16x32_bf16 v[212:215], v[120:123], v[48:51], v[212:215]
    ds_read_b64_tr_b16 v[70:71], v20 offset:32000
    v_mfma_f32_16x16x32_bf16 v[140:143], v[108:111], v[36:39], v[140:143]
    ds_read_b64_tr_b16 v[56:57], v17 offset:30720
    v_mfma_f32_16x16x32_bf16 v[160:163], v[112:115], v[36:39], v[160:163]
    v_mfma_f32_16x16x32_bf16 v[180:183], v[116:119], v[36:39], v[180:183]
    ds_read_b64_tr_b16 v[58:59], v17 offset:32000
    s_add_u32 m0, s19, 40960
    v_mfma_f32_16x16x32_bf16 v[200:203], v[120:123], v[36:39], v[200:203]
    s_add_u32 s20, s27, 0
    buffer_load_dwordx4 v220, s[12:15], s20 offen lds
    ds_read_b64_tr_b16 v[60:61], v18 offset:30720
    v_mfma_f32_16x16x32_bf16 v[144:147], v[108:111], v[40:43], v[144:147]
    ds_read_b64_tr_b16 v[62:63], v18 offset:32000
    v_mfma_f32_16x16x32_bf16 v[164:167], v[112:115], v[40:43], v[164:167]
    v_mfma_f32_16x16x32_bf16 v[184:187], v[116:119], v[40:43], v[184:187]
    v_mfma_f32_16x16x32_bf16 v[204:207], v[120:123], v[40:43], v[204:207]
    s_mov_b32 vcc_lo, 0x00ff00ff
    s_mov_b32 vcc_hi, 0x00ff00ff
    s_waitcnt lgkmcnt(8)
    v_mfma_f32_16x16x32_bf16 v[156:159], v[124:127], v[72:75], v[156:159]
    v_mfma_f32_16x16x32_bf16 v[176:179], v[128:131], v[72:75], v[176:179]
    v_mfma_f32_16x16x32_bf16 v[196:199], v[132:135], v[72:75], v[196:199]
    v_mfma_f32_16x16x32_bf16 v[216:219], v[136:139], v[72:75], v[216:219]
    s_waitcnt lgkmcnt(0)
    s_barrier
    v_mfma_f32_16x16x32_bf16 v[148:151], v[124:127], v[64:67], v[148:151]
    s_add_u32 m0, s19, 45056
    v_mfma_f32_16x16x32_bf16 v[168:171], v[128:131], v[64:67], v[168:171]
    s_add_u32 s20, s27, 20480
    buffer_load_dwordx4 v220, s[12:15], s20 offen lds
    v_mfma_f32_16x16x32_bf16 v[188:191], v[132:135], v[64:67], v[188:191]
    v_mfma_f32_16x16x32_bf16 v[208:211], v[136:139], v[64:67], v[208:211]
    v_cvt_pk_bf16_f32 v76, v156, v157
    v_cvt_pk_bf16_f32 v77, v158, v159
    v_mfma_f32_16x16x32_bf16 v[152:155], v[124:127], v[68:71], v[152:155]
    v_cndmask_b32 v76, v76, v232, vcc
    v_cndmask_b32 v77, v77, v232, vcc
    v_mfma_f32_16x16x32_bf16 v[172:175], v[128:131], v[68:71], v[172:175]
    v_cvt_pk_bf16_f32 v78, v176, v177
    v_cvt_pk_bf16_f32 v79, v178, v179
    s_add_u32 m0, s19, 49152
    v_mfma_f32_16x16x32_bf16 v[192:195], v[132:135], v[68:71], v[192:195]
    s_add_u32 s20, s27, 40960
    buffer_load_dwordx4 v220, s[12:15], s20 offen lds
    v_mfma_f32_16x16x32_bf16 v[212:215], v[136:139], v[68:71], v[212:215]
    v_cndmask_b32 v78, v78, v232, vcc
    v_cndmask_b32 v79, v79, v232, vcc
    v_mfma_f32_16x16x32_bf16 v[140:143], v[124:127], v[56:59], v[140:143]
    v_cvt_pk_bf16_f32 v80, v196, v197
    v_cvt_pk_bf16_f32 v81, v198, v199
    v_mfma_f32_16x16x32_bf16 v[160:163], v[128:131], v[56:59], v[160:163]
    v_cndmask_b32 v80, v80, v232, vcc
    v_cndmask_b32 v81, v81, v232, vcc
    v_mfma_f32_16x16x32_bf16 v[180:183], v[132:135], v[56:59], v[180:183]
    v_cvt_pk_bf16_f32 v82, v216, v217
    v_cvt_pk_bf16_f32 v83, v218, v219
    s_add_u32 m0, s19, 16384
    v_mfma_f32_16x16x32_bf16 v[200:203], v[136:139], v[56:59], v[200:203]
    s_add_u32 s20, s26, 81920
    buffer_load_dwordx4 v220, s[12:15], s20 offen lds
    v_mfma_f32_16x16x32_bf16 v[144:147], v[124:127], v[60:63], v[144:147]
    v_cndmask_b32 v82, v82, v232, vcc
    v_cndmask_b32 v83, v83, v232, vcc
    v_mfma_f32_16x16x32_bf16 v[164:167], v[128:131], v[60:63], v[164:167]
    v_mov_b32_dpp v156, v196 row_shr:8 row_mask:0xf bank_mask:0xc
    v_mov_b32_dpp v157, v197 row_shr:8 row_mask:0xf bank_mask:0xc
    v_mfma_f32_16x16x32_bf16 v[184:187], v[132:135], v[60:63], v[184:187]
    v_mov_b32_dpp v158, v198 row_shr:8 row_mask:0xf bank_mask:0xc
    v_mov_b32_dpp v159, v199 row_shr:8 row_mask:0xf bank_mask:0xc
    v_mfma_f32_16x16x32_bf16 v[204:207], v[136:139], v[60:63], v[204:207]
    v_mov_b32_dpp v176, v216 row_shr:8 row_mask:0xf bank_mask:0xc
    v_mov_b32_dpp v177, v217 row_shr:8 row_mask:0xf bank_mask:0xc
    v_mov_b32_dpp v178, v218 row_shr:8 row_mask:0xf bank_mask:0xc
    v_mov_b32_dpp v179, v219 row_shr:8 row_mask:0xf bank_mask:0xc
    v_mul_f32 v112, s60, v156
    v_mul_f32 v113, s61, v157
    v_mul_f32 v114, s60, v158
    v_mul_f32 v115, s61, v159
    v_exp_f32 v112, v112 clamp
    v_exp_f32 v113, v113 clamp
    v_exp_f32 v114, v114 clamp
    v_exp_f32 v115, v115 clamp
    v_max_f32 v156, s62, v156
    v_max_f32 v157, s62, v157
    v_max_f32 v158, s62, v158
    v_max_f32 v159, s62, v159
    v_add_f32 v112, v112, v156
    v_add_f32 v113, v113, v157
    v_add_f32 v114, v114, v158
    v_add_f32 v115, v115, v159
    v_cvt_pk_bf16_f32 v68, v112, v113
    s_add_u32 m0, s19, 20480
    s_add_u32 s20, s26, 102400
    buffer_load_dwordx4 v220, s[12:15], s20 offen lds
    s_add_u32 m0, s19, 24576
    s_add_u32 s20, s26, 122880
    buffer_load_dwordx4 v220, s[12:15], s20 offen lds
    s_add_u32 m0, s19, 28672
    s_add_u32 s20, s26, 143360
    buffer_load_dwordx4 v220, s[12:15], s20 offen lds
    v_cvt_pk_bf16_f32 v69, v114, v115
    v_mul_f32 v116, s60, v176
    v_mul_f32 v117, s61, v177
    v_mul_f32 v118, s60, v178
    v_mul_f32 v119, s61, v179
    v_exp_f32 v116, v116 clamp
    v_exp_f32 v117, v117 clamp
    v_exp_f32 v118, v118 clamp
    v_exp_f32 v119, v119 clamp
    v_max_f32 v176, s62, v176
    v_max_f32 v177, s62, v177
    v_max_f32 v178, s62, v178
    v_max_f32 v179, s62, v179
    v_add_f32 v116, v116, v176
    v_add_f32 v117, v117, v177
    v_add_f32 v118, v118, v178
    v_add_f32 v119, v119, v179
    v_cvt_pk_bf16_f32 v70, v116, v117
    v_cvt_pk_bf16_f32 v71, v118, v119
    s_add_u32 m0, s19, 53248
    s_add_u32 s20, s27, 61440
    buffer_load_dwordx4 v220, s[12:15], s20 offen lds
    s_add_u32 m0, s19, 57344
    s_add_u32 s20, s27, 81920
    buffer_load_dwordx4 v220, s[12:15], s20 offen lds
    v_cvt_pk_bf16_f32 v52, v148, v149
    v_cvt_pk_bf16_f32 v53, v150, v151
    v_cvt_pk_bf16_f32 v60, v152, v153
    v_cvt_pk_bf16_f32 v61, v154, v155
    v_cvt_pk_bf16_f32 v54, v168, v169
    v_cvt_pk_bf16_f32 v55, v170, v171
    v_cvt_pk_bf16_f32 v62, v172, v173
    v_cvt_pk_bf16_f32 v63, v174, v175
    v_mov_b32_dpp v72, v68 row_ror:8 row_mask:0xf bank_mask:0xf
    v_mov_b32_dpp v73, v69 row_ror:8 row_mask:0xf bank_mask:0xf
    v_mov_b32_dpp v74, v70 row_ror:8 row_mask:0xf bank_mask:0xf
    v_mov_b32_dpp v75, v71 row_ror:8 row_mask:0xf bank_mask:0xf
    v_cvt_pk_bf16_f32 v56, v188, v189
    v_cvt_pk_bf16_f32 v57, v190, v191
    v_cvt_pk_bf16_f32 v64, v192, v193
    v_cvt_pk_bf16_f32 v65, v194, v195
    v_cvt_pk_bf16_f32 v58, v208, v209
    v_cvt_pk_bf16_f32 v59, v210, v211
    v_cvt_pk_bf16_f32 v66, v212, v213
    v_cvt_pk_bf16_f32 v67, v214, v215
    v_mul_f32 v112, s60, v140
    v_mul_f32 v113, s61, v141
    v_mul_f32 v114, s60, v142
    v_mul_f32 v115, s61, v143
    v_exp_f32 v112, v112 clamp
    v_exp_f32 v113, v113 clamp
    v_mfma_f32_16x16x32_bf16 v[100:103], v[68:71], v[52:55], 0
    v_exp_f32 v114, v114 clamp
    v_exp_f32 v115, v115 clamp
    v_max_f32 v140, s62, v140
    v_max_f32 v141, s62, v141
    v_mfma_f32_16x16x32_bf16 v[104:107], v[68:71], v[60:63], 0
    v_max_f32 v142, s62, v142
    v_max_f32 v143, s62, v143
    v_add_f32 v112, v112, v140
    v_add_f32 v113, v113, v141
    v_add_f32 v114, v114, v142
    v_add_f32 v115, v115, v143
    v_mfma_f32_16x16x32_bf16 v[108:111], v[68:71], v[76:79], 0
    v_cvt_pk_bf16_f32 v36, v112, v113
    v_cvt_pk_bf16_f32 v37, v114, v115
    v_mul_f32 v116, s60, v160
    v_mul_f32 v117, s61, v161
    v_mul_f32 v118, s60, v162
    v_mul_f32 v119, s61, v163
    v_mfma_f32_16x16x32_bf16 v[100:103], v[72:75], v[56:59], v[100:103]
    v_exp_f32 v116, v116 clamp
    v_exp_f32 v117, v117 clamp
    v_exp_f32 v118, v118 clamp
    v_exp_f32 v119, v119 clamp
    v_mfma_f32_16x16x32_bf16 v[104:107], v[72:75], v[64:67], v[104:107]
    v_max_f32 v160, s62, v160
    v_max_f32 v161, s62, v161
    v_max_f32 v162, s62, v162
    v_max_f32 v163, s62, v163
    v_mfma_f32_16x16x32_bf16 v[108:111], v[72:75], v[80:83], v[108:111]
    v_add_f32 v116, v116, v160
    v_add_f32 v117, v117, v161
    v_add_f32 v118, v118, v162
    v_add_f32 v119, v119, v163
    v_cvt_pk_bf16_f32 v38, v116, v117
    v_cvt_pk_bf16_f32 v39, v118, v119
    v_mul_f32 v112, s60, v180
    v_mul_f32 v113, s61, v181
    v_mul_f32 v114, s60, v182
    v_mul_f32 v115, s61, v183
    v_exp_f32 v112, v112 clamp
    v_exp_f32 v113, v113 clamp
    v_exp_f32 v114, v114 clamp
    v_mfma_f32_16x16x32_bf16 v[84:87], v[36:39], v[52:55], 0
    v_exp_f32 v115, v115 clamp
    v_max_f32 v180, s62, v180
    v_max_f32 v181, s62, v181
    v_max_f32 v182, s62, v182
    v_max_f32 v183, s62, v183
    v_mfma_f32_16x16x32_bf16 v[92:95], v[36:39], v[76:79], 0
    v_add_f32 v112, v112, v180
    v_add_f32 v113, v113, v181
    v_add_f32 v114, v114, v182
    v_add_f32 v115, v115, v183
    v_cvt_pk_bf16_f32 v40, v112, v113
    v_cvt_pk_bf16_f32 v41, v114, v115
    v_mul_f32 v116, s60, v200
    v_mul_f32 v117, s61, v201
    v_cndmask_b32 v100, v100, v104, s[22:23]
    v_cndmask_b32 v101, v101, v105, s[22:23]
    v_cndmask_b32 v102, v102, v106, s[22:23]
    v_cndmask_b32 v103, v103, v107, s[22:23]
    v_mul_f32 v118, s60, v202
    v_mul_f32 v119, s61, v203
    v_exp_f32 v116, v116 clamp
    v_exp_f32 v117, v117 clamp
    v_exp_f32 v118, v118 clamp
    v_exp_f32 v119, v119 clamp
    s_mov_b32 exec_lo, 0xf0010f01
    s_mov_b32 exec_hi, 0
    ds_write_b128 v228, v[108:111] offset:64
    s_mov_b64 exec, -1
    v_max_f32 v200, s62, v200
    v_max_f32 v201, s62, v201
    v_max_f32 v202, s62, v202
    v_max_f32 v203, s62, v203
    v_add_f32 v116, v116, v200
    v_add_f32 v117, v117, v201
    v_add_f32 v118, v118, v202
    v_add_f32 v119, v119, v203
    v_cvt_pk_bf16_f32 v42, v116, v117
    v_cvt_pk_bf16_f32 v43, v118, v119
    v_mul_f32 v112, s60, v144
    v_mul_f32 v113, s61, v145
    v_mul_f32 v114, s60, v146
    v_mul_f32 v115, s61, v147
    v_exp_f32 v112, v112 clamp
    v_exp_f32 v113, v113 clamp
    v_exp_f32 v114, v114 clamp
    v_exp_f32 v115, v115 clamp
    v_max_f32 v144, s62, v144
    v_mfma_f32_16x16x32_bf16 v[84:87], v[40:43], v[56:59], v[84:87]
    v_max_f32 v145, s62, v145
    v_max_f32 v146, s62, v146
    v_max_f32 v147, s62, v147
    v_add_f32 v112, v112, v144
    v_add_f32 v113, v113, v145
    v_add_f32 v114, v114, v146
    v_add_f32 v115, v115, v147
    v_cvt_pk_bf16_f32 v44, v112, v113
    v_cvt_pk_bf16_f32 v45, v114, v115
    v_mfma_f32_16x16x32_bf16 v[92:95], v[40:43], v[80:83], v[92:95]
    v_mul_f32 v116, s60, v164
    v_mul_f32 v117, s61, v165
    v_mul_f32 v118, s60, v166
    v_mul_f32 v119, s61, v167
    v_exp_f32 v116, v116 clamp
    v_exp_f32 v117, v117 clamp
    v_exp_f32 v118, v118 clamp
    v_exp_f32 v119, v119 clamp
    v_max_f32 v164, s62, v164
    s_mov_b32 exec_lo, -1
    s_mov_b32 exec_hi, 0
    ds_write_b128 v224, v[100:103] offset:64
    s_mov_b64 exec, -1
    v_max_f32 v165, s62, v165
    v_max_f32 v166, s62, v166
    v_max_f32 v167, s62, v167
    v_add_f32 v116, v116, v164
    v_add_f32 v117, v117, v165
    v_add_f32 v118, v118, v166
    v_add_f32 v119, v119, v167
    v_cvt_pk_bf16_f32 v46, v116, v117
    v_cvt_pk_bf16_f32 v47, v118, v119
    v_mul_f32 v112, s60, v184
    v_mul_f32 v113, s61, v185
    v_mul_f32 v114, s60, v186
    v_mul_f32 v115, s61, v187
    v_exp_f32 v112, v112 clamp
    v_exp_f32 v113, v113 clamp
    v_exp_f32 v114, v114 clamp
    v_mfma_f32_16x16x32_bf16 v[88:91], v[44:47], v[60:63], 0
    v_exp_f32 v115, v115 clamp
    v_max_f32 v184, s62, v184
    v_max_f32 v185, s62, v185
    v_max_f32 v186, s62, v186
    v_max_f32 v187, s62, v187
    v_mfma_f32_16x16x32_bf16 v[96:99], v[44:47], v[76:79], 0
    v_add_f32 v112, v112, v184
    v_add_f32 v113, v113, v185
    v_add_f32 v114, v114, v186
    v_add_f32 v115, v115, v187
    v_cvt_pk_bf16_f32 v48, v112, v113
    v_cvt_pk_bf16_f32 v49, v114, v115
    v_mul_f32 v116, s60, v204
    v_mul_f32 v117, s61, v205
    ds_write_b128 v225, v[84:87]
    v_mul_f32 v118, s60, v206
    v_mul_f32 v119, s61, v207
    v_exp_f32 v116, v116 clamp
    v_exp_f32 v117, v117 clamp
    v_exp_f32 v118, v118 clamp
    v_exp_f32 v119, v119 clamp
    s_mov_b32 exec_lo, 0x0f010f01
    s_mov_b32 exec_hi, 0x0f010f01
    ds_write_b128 v227, v[92:95] offset:0
    s_mov_b64 exec, -1
    v_max_f32 v204, s62, v204
    v_max_f32 v205, s62, v205
    v_max_f32 v206, s62, v206
    v_max_f32 v207, s62, v207
    v_add_f32 v116, v116, v204
    v_add_f32 v117, v117, v205
    v_add_f32 v118, v118, v206
    v_add_f32 v119, v119, v207
    v_cvt_pk_bf16_f32 v50, v116, v117
    v_cvt_pk_bf16_f32 v51, v118, v119
    s_nop 1
    v_mfma_f32_16x16x32_bf16 v[88:91], v[48:51], v[64:67], v[88:91]
    v_mfma_f32_16x16x32_bf16 v[96:99], v[48:51], v[80:83], v[96:99]
    s_mov_b32 s66, 300000
    s_branch poll1c
poll1:
    global_load_dword v7, v6, s[36:37] sc1
poll1c:
    s_waitcnt vmcnt(0)
    v_cmp_le_u32 vcc, 64, v7
    s_nop 0
    s_and_b32 vcc_lo, vcc_lo, 1
    s_cmp_eq_u32 vcc_lo, 1
    s_cbranch_scc1 poll1d
    s_sleep 2
    s_sub_u32 s66, s66, 1
    s_cmp_lg_u32 s66, 0
    s_cbranch_scc1 poll1
poll1d:
    ds_write_b128 v225, v[88:91] offset:1680
    s_mov_b32 exec_lo, 0xf001f001
    s_mov_b32 exec_hi, 0xf001f001
    ds_write_b128 v227, v[96:99] offset:1680
    s_mov_b64 exec, -1
    v_cmp_gt_u32 vcc, 144, v0
    s_waitcnt lgkmcnt(0)
    s_barrier
    ds_read2st64_b32 v[12:13], v229 offset0:0 offset1:27
    ds_read2st64_b32 v[14:15], v229 offset0:4 offset1:31
    ds_read2st64_b32 v[16:17], v229 offset0:8 offset1:35
    ds_read2st64_b32 v[18:19], v229 offset0:12 offset1:39
    ds_read2st64_b32 v[20:21], v229 offset0:16 offset1:43
    ds_read2st64_b32 v[22:23], v229 offset0:20 offset1:47
    ds_read2st64_b32 v[24:25], v229 offset0:24 offset1:51
    s_waitcnt lgkmcnt(6)
    v_add_f32 v12, v12, v13
    global_atomic_add_f32 v230, v12, s[38:39] offset:0
    s_waitcnt lgkmcnt(5)
    v_add_f32 v14, v14, v15
    global_atomic_add_f32 v230, v14, s[38:39] offset:1024
    s_waitcnt lgkmcnt(4)
    v_add_f32 v16, v16, v17
    global_atomic_add_f32 v230, v16, s[38:39] offset:2048
    s_waitcnt lgkmcnt(3)
    v_add_f32 v18, v18, v19
    global_atomic_add_f32 v230, v18, s[38:39] offset:3072
    s_waitcnt lgkmcnt(2)
    v_add_f32 v20, v20, v21
    global_atomic_add_f32 v231, v20, s[38:39] offset:0
    s_waitcnt lgkmcnt(1)
    v_add_f32 v22, v22, v23
    global_atomic_add_f32 v231, v22, s[38:39] offset:1024
    s_waitcnt lgkmcnt(0)
    v_add_f32 v24, v24, v25
    s_and_saveexec_b64 s[58:59], vcc
    s_cbranch_execz KV_skip
    global_atomic_add_f32 v231, v24, s[38:39] offset:2048
KV_skip:
    s_mov_b64 exec, -1
    s_lshr_b32 s41, s4, 1
    s_lshl_b32 s41, s41, 8
    s_add_u32 s41, s41, 6411264
    v_lshl_add_u32 v5, v1, 10, s41
    ds_read_b64_tr_b16 v[96:97], v234 offset:0
    ds_read_b64_tr_b16 v[98:99], v234 offset:5120
    ds_read_b64_tr_b16 v[100:101], v234 offset:2048
    ds_read_b64_tr_b16 v[102:103], v234 offset:7168
    ds_read_b64_tr_b16 v[104:105], v234 offset:10240
    ds_read_b64_tr_b16 v[106:107], v234 offset:15360
    ds_read_b64_tr_b16 v[108:109], v234 offset:12288
    ds_read_b64_tr_b16 v[110:111], v234 offset:17408
    ds_read_b64_tr_b16 v[128:129], v235 offset:0
    ds_read_b64_tr_b16 v[132:133], v235 offset:10240
    ds_read_b64_tr_b16 v[112:113], v234 offset:20480
    ds_read_b64_tr_b16 v[114:115], v234 offset:25600
    ds_read_b64_tr_b16 v[116:117], v234 offset:22528
    ds_read_b64_tr_b16 v[118:119], v234 offset:27648
    ds_read_b64_tr_b16 v[120:121], v234 offset:30720
    ds_read_b64_tr_b16 v[122:123], v234 offset:35840
    ds_read_b64_tr_b16 v[124:125], v234 offset:32768
    ds_read_b64_tr_b16 v[126:127], v234 offset:37888
    ds_read_b64_tr_b16 v[130:131], v235 offset:20480
    ds_read_b64_tr_b16 v[134:135], v235 offset:30720
    ds_read_b64_tr_b16 v[136:137], v236 offset:0
    ds_read_b64_tr_b16 v[138:139], v236 offset:5120
    ds_read_b64_tr_b16 v[140:141], v236 offset:2048
    ds_read_b64_tr_b16 v[142:143], v236 offset:7168
    ds_read_b64_tr_b16 v[144:145], v236 offset:10240
    ds_read_b64_tr_b16 v[146:147], v236 offset:15360
    ds_read_b64_tr_b16 v[148:149], v236 offset:12288
    ds_read_b64_tr_b16 v[150:151], v236 offset:17408
    ds_read_b64_tr_b16 v[168:169], v237 offset:0
    ds_read_b64_tr_b16 v[172:173], v237 offset:10240
    s_waitcnt vmcnt(8) lgkmcnt(0)
    s_barrier
    s_cmp_lg_u32 s40, 3
    s_cbranch_scc1 KV_nosig
    v_mov_b32 v2, 1
    s_mov_b64 exec, 65535
    global_atomic_add v5, v2, s[38:39] sc1
    s_mov_b64 exec, -1
    s_mov_b32 s10, 1
    v_add_u32 v63, 128, v5
KV_nosig:
    s_add_u32 m0, s19, 61440
    s_add_u32 s20, s27, 102400
    buffer_load_dwordx4 v220, s[12:15], s20 offen lds
    s_add_u32 m0, s19, 65536
    s_add_u32 s20, s27, 122880
    buffer_load_dwordx4 v220, s[12:15], s20 offen lds
    s_add_u32 m0, s19, 69632
    s_add_u32 s20, s27, 143360
    buffer_load_dwordx4 v220, s[12:15], s20 offen lds
    s_add_u32 m0, s19, 73728
    s_add_u32 s20, s27, 163840
    buffer_load_dwordx4 v220, s[12:15], s20 offen lds
    s_add_u32 m0, s19, 77824
    s_add_u32 s20, s27, 184320
    buffer_load_dwordx4 v220, s[12:15], s20 offen lds
    s_branch F_entry
Q_comp:
    v_and_b32 v42, 15, v1
    v_lshrrev_b32 v43, 4, v1
    v_lshrrev_b32 v44, 1, v42
    v_xor_b32 v44, v44, v43
    v_lshlrev_b32 v45, 7, v42
    s_lshl_b32 s41, s56, 13
    v_add_u32 v45, s41, v45
    v_lshl_add_u32 v2, v44, 4, v45
    v_xor_b32 v3, 64, v2
    v_lshrrev_b32 v44, 2, v42
    v_and_b32 v45, 3, v42
    v_lshl_add_u32 v44, v43, 3, v44
    v_mul_u32_u24 v44, 320, v44
    v_add_u32 v44, 32768, v44
    v_and_b32 v46, 1, v43
    v_lshlrev_b32 v46, 5, v46
    s_mul_i32 s41, s57, 160
    s_add_u32 s42, s41, 0
    v_lshl_add_u32 v47, v45, 3, s42
    v_xor_b32 v47, v47, v46
    v_add_u32 v17, v47, v44
    s_add_u32 s42, s41, 40
    v_lshl_add_u32 v47, v45, 3, s42
    v_xor_b32 v47, v47, v46
    v_add_u32 v18, v47, v44
    s_add_u32 s42, s41, 80
    v_lshl_add_u32 v47, v45, 3, s42
    v_xor_b32 v47, v47, v46
    v_add_u32 v19, v47, v44
    s_add_u32 s42, s41, 120
    v_lshl_add_u32 v47, v45, 3, s42
    v_xor_b32 v47, v47, v46
    v_add_u32 v20, v47, v44
    s_add_u32 s42, s41, 32
    v_mul_u32_u24 v47, 40, v45
    v_add_u32 v47, s42, v47
    v_xor_b32 v47, v47, v46
    v_add_u32 v21, v47, v44
    v_mov_b32 v4, 0
    v_mov_b32 v5, 0
    v_mov_b32 v140, v4
    v_mov_b32 v141, v4
    v_mov_b32 v142, v4
    v_mov_b32 v143, v4
    v_mov_b32 v144, v4
    v_mov_b32 v145, v4
    v_mov_b32 v146, v4
    v_mov_b32 v147, v4
    v_mov_b32 v148, v4
    v_mov_b32 v149, v4
    v_mov_b32 v150, v4
    v_mov_b32 v151, v4
    v_mov_b32 v152, v4
    v_mov_b32 v153, v4
    v_mov_b32 v154, v4
    v_mov_b32 v155, v4
    v_mov_b32 v156, v4
    v_mov_b32 v157, v4
    v_mov_b32 v158, v4
    v_mov_b32 v159, v4
    v_mov_b32 v160, v4
    v_mov_b32 v161, v4
    v_mov_b32 v162, v4
    v_mov_b32 v163, v4
    v_mov_b32 v164, v4
    v_mov_b32 v165, v4
    v_mov_b32 v166, v4
    v_mov_b32 v167, v4
    v_mov_b32 v168, v4
    v_mov_b32 v169, v4
    v_mov_b32 v170, v4
    v_mov_b32 v171, v4
    v_mov_b32 v172, v4
    v_mov_b32 v173, v4
    v_mov_b32 v174, v4
    v_mov_b32 v175, v4
    v_mov_b32 v176, v4
    v_mov_b32 v177, v4
    v_mov_b32 v178, v4
    v_mov_b32 v179, v4
    v_mov_b32 v180, v4
    v_mov_b32 v181, v4
    v_mov_b32 v182, v4
    v_mov_b32 v183, v4
    v_mov_b32 v184, v4
    v_mov_b32 v185, v4
    v_mov_b32 v186, v4
    v_mov_b32 v187, v4
    v_mov_b32 v188, v4
    v_mov_b32 v189, v4
    v_mov_b32 v190, v4
    v_mov_b32 v191, v4
    v_mov_b32 v192, v4
    v_mov_b32 v193, v4
    v_mov_b32 v194, v4
    v_mov_b32 v195, v4
    v_mov_b32 v196, v4
    v_mov_b32 v197, v4
    v_mov_b32 v198, v4
    v_mov_b32 v199, v4
    v_mov_b32 v200, v4
    v_mov_b32 v201, v4
    v_mov_b32 v202, v4
    v_mov_b32 v203, v4
    v_mov_b32 v204, v4
    v_mov_b32 v205, v4
    v_mov_b32 v206, v4
    v_mov_b32 v207, v4
    v_mov_b32 v208, v4
    v_mov_b32 v209, v4
    v_mov_b32 v210, v4
    v_mov_b32 v211, v4
    v_mov_b32 v212, v4
    v_mov_b32 v213, v4
    v_mov_b32 v214, v4
    v_mov_b32 v215, v4
    v_mov_b32 v216, v4
    v_mov_b32 v217, v4
    v_mov_b32 v218, v4
    v_mov_b32 v219, v4
    s_lshl_b32 s41, s3, 1
    s_add_u32 s41, s41, s56
    s_lshl_b32 s41, s41, 2
    s_and_b32 s42, s4, 1
    s_add_u32 s42, s42, s41
    s_lshl_b32 s42, s42, 6
    s_add_u32 s42, s42, 6291456
    v_lshl_add_u32 v226, v42, 2, s42
    v_lshrrev_b32 v44, 5, v1
    v_lshl_add_u32 v226, v44, 7, v226
    s_mul_i32 s42, s57, 6784
    v_mul_u32_u24 v220, 80, v42
    v_add_u32 v220, s42, v220
    v_lshl_add_u32 v221, v43, 4, v220
    v_lshrrev_b32 v44, 2, v42
    v_and_b32 v45, 3, v42
    v_mul_u32_u24 v222, 1680, v44
    v_mul_u32_u24 v223, 80, v45
    v_add3_u32 v222, v222, v223, s42
    v_lshl_add_u32 v223, v43, 4, v222
    v_mul_u32_u24 v224, 1680, v45
    v_add_u32 v224, s42, v224
    v_lshl_add_u32 v225, v43, 4, v224
    s_mul_i32 s20, s4, 10240
    s_add_u32 s20, s20, 3145728
    s_mul_i32 s21, s41, 20480
    s_add_u32 s20, s20, s21
    s_lshl_b32 s21, s57, 11
    s_add_u32 s21, s21, s20
    v_lshl_add_u32 v46, v1, 4, s21
    s_lshl_b32 s21, s57, 10
    s_add_u32 s21, s21, s20
    s_add_u32 s21, s21, 8192
    v_lshl_add_u32 v47, v1, 4, s21
    s_and_b32 s20, s4, 0
    s_lshl_b32 s20, s20, 12
    s_sub_u32 s21, 4096, s20
    v_add_u32 v236, s20, v46
    v_add_u32 v237, s21, v46
    v_add_u32 v240, 0, v47
    v_add_u32 v238, 40960, v236
    v_add_u32 v239, 40960, v237
    v_add_u32 v241, 40960, v47
    v_cmp_eq_u32 s[20:21], 0, v43
    v_cmp_eq_u32 s[22:23], 1, v43
    s_nop 0
    v_cndmask_b32 v242, 0, -1, s[20:21]
    v_cmp_eq_u32 s[20:21], 2, v43
    v_cndmask_b32 v243, 0, -1, s[22:23]
    v_cmp_eq_u32 s[22:23], 3, v43
    v_cndmask_b32 v244, 0, -1, s[20:21]
    v_cmp_eq_u32 s[20:21], 0, v45
    v_cndmask_b32 v245, 0, -1, s[22:23]
    v_cmp_eq_u32 s[22:23], 1, v45
    v_cndmask_b32 v246, 0, -1, s[20:21]
    v_cmp_eq_u32 s[20:21], 2, v45
    v_cndmask_b32 v247, 0, -1, s[22:23]
    v_cmp_eq_u32 s[22:23], 3, v45
    v_cndmask_b32 v248, 0, -1, s[20:21]
    v_cmp_eq_u32 s[20:21], 0, v44
    v_cndmask_b32 v249, 0, -1, s[22:23]
    v_cmp_eq_u32 s[22:23], 1, v44
    v_cndmask_b32 v250, 0, -1, s[20:21]
    v_cmp_eq_u32 s[20:21], 2, v44
    v_cndmask_b32 v251, 0, -1, s[22:23]
    v_cmp_eq_u32 s[22:23], 3, v44
    v_cndmask_b32 v252, 0, -1, s[20:21]
    v_cmp_eq_u32 s[20:21], v43, v45
    v_cndmask_b32 v253, 0, -1, s[22:23]
    v_cmp_eq_u32 s[22:23], v43, v44
    v_cndmask_b32 v254, 0, -1, s[20:21]
    s_nop 0
    v_cndmask_b32 v255, 0, -1, s[22:23]
    s_lshl_b32 s20, s3, 2
    s_add_u32 s20, s20, s4
    s_lshl_b32 s20, s20, 8
    s_add_u32 s20, s20, 6411264
    v_mov_b32 v227, s20
    s_mul_i32 s20, s41, 320
    s_add_u32 s20, s20, 6427648
    v_lshl_add_u32 v228, v1, 8, s20
    v_lshlrev_b32 v229, 4, v1
    s_lshl_b32 s60, s2, 8
    s_add_u32 s60, s60, 6815744
    v_mov_b32 v4, s60
    v_mov_b32 v5, 1
    v_mov_b32 v6, 0
    s_mov_b32 s60, 0x3fb8aa3b
    s_mov_b32 s61, 0x3fb8aa3b
    s_mov_b32 s62, 0x358637bd
    v_mov_b32 v36, -1
    v_mov_b32 v37, -1
    v_mov_b32 v38, -1
    v_mov_b32 v39, -1
    s_waitcnt vmcnt(0)
    s_add_u32 m0, s46, 0
    s_nop 0
    buffer_load_dwordx4 v8, s[48:51], s43 offen lds
    s_add_u32 m0, s46, 4096
    s_nop 0
    buffer_load_dwordx4 v9, s[48:51], s43 offen lds
    s_add_u32 m0, s46, 8192
    s_nop 0
    buffer_load_dwordx4 v10, s[48:51], s43 offen lds
    s_add_u32 m0, s46, 12288
    s_nop 0
    buffer_load_dwordx4 v11, s[48:51], s43 offen lds
    s_add_u32 m0, s47, 0
    s_nop 0
    buffer_load_dwordx4 v12, s[52:55], s44 offen lds
    s_add_u32 m0, s47, 4096
    s_nop 0
    buffer_load_dwordx4 v13, s[52:55], s44 offen lds
    s_add_u32 m0, s47, 8192
    s_nop 0
    buffer_load_dwordx4 v14, s[52:55], s44 offen lds
    s_add_u32 m0, s47, 12288
    s_nop 0
    buffer_load_dwordx4 v15, s[52:55], s44 offen lds
    s_add_u32 m0, s47, 16384
    s_nop 0
    buffer_load_dwordx4 v16, s[52:55], s44 offen lds
    s_and_b32 s44, s64, 15
    s_lshr_b64 s[64:65], s[64:65], 4
    s_lshl_b32 s43, s44, 7
    s_mul_i32 s44, s44, 245760
    s_add_u32 m0, s46, 16384
    s_nop 0
    buffer_load_dwordx4 v8, s[48:51], s43 offen lds
    s_add_u32 m0, s47, 20480
    s_nop 0
    buffer_load_dwordx4 v12, s[52:55], s44 offen lds
    s_add_u32 m0, s46, 20480
    s_nop 0
    buffer_load_dwordx4 v9, s[48:51], s43 offen lds
    s_add_u32 m0, s47, 24576
    s_nop 0
    buffer_load_dwordx4 v13, s[52:55], s44 offen lds
    s_add_u32 m0, s46, 24576
    s_nop 0
    buffer_load_dwordx4 v10, s[48:51], s43 offen lds
    s_add_u32 m0, s47, 28672
    s_nop 0
    buffer_load_dwordx4 v14, s[52:55], s44 offen lds
    s_add_u32 m0, s46, 28672
    s_nop 0
    buffer_load_dwordx4 v11, s[48:51], s43 offen lds
    s_add_u32 m0, s47, 32768
    s_nop 0
    buffer_load_dwordx4 v15, s[52:55], s44 offen lds
    s_add_u32 m0, s47, 36864
    s_nop 0
    buffer_load_dwordx4 v16, s[52:55], s44 offen lds
    s_and_b32 s44, s64, 15
    s_lshr_b64 s[64:65], s[64:65], 4
    s_lshl_b32 s43, s44, 7
    s_mul_i32 s44, s44, 245760
    s_waitcnt vmcnt(11) lgkmcnt(0)
    s_barrier
    ds_read_b128 v[76:79], v2 offset:0
    ds_read_b128 v[80:83], v2 offset:2048
    ds_read_b128 v[84:87], v2 offset:4096
    ds_read_b128 v[88:91], v2 offset:6144
    ds_read_b64_tr_b16 v[36:37], v17 offset:0
    ds_read_b64_tr_b16 v[38:39], v17 offset:1280
    ds_read_b64_tr_b16 v[40:41], v18 offset:0
    ds_read_b64_tr_b16 v[42:43], v18 offset:1280
    ds_read_b64_tr_b16 v[52:53], v21 offset:0
    ds_read_b64_tr_b16 v[54:55], v21 offset:1280
    ds_read_b64_tr_b16 v[44:45], v19 offset:0
    ds_read_b64_tr_b16 v[46:47], v19 offset:1280
    ds_read_b64_tr_b16 v[48:49], v20 offset:0
    ds_read_b64_tr_b16 v[50:51], v20 offset:1280
    ds_read_b128 v[92:95], v3 offset:0
    ds_read_b128 v[96:99], v3 offset:2048
    ds_read_b128 v[100:103], v3 offset:4096
    ds_read_b128 v[104:107], v3 offset:6144
    s_mov_b32 s45, 4
.p2align 3
Q_loop:
    s_waitcnt lgkmcnt(12)
    v_mfma_f32_16x16x32_bf16 v[140:143], v[36:39], v[76:79], v[140:143]
    v_mfma_f32_16x16x32_bf16 v[160:163], v[36:39], v[80:83], v[160:163]
    v_mfma_f32_16x16x32_bf16 v[180:183], v[36:39], v[84:87], v[180:183]
    v_mfma_f32_16x16x32_bf16 v[200:203], v[36:39], v[88:91], v[200:203]
    s_waitcnt vmcnt(9) lgkmcnt(0)
    s_barrier
    v_mfma_f32_16x16x32_bf16 v[144:147], v[40:43], v[76:79], v[144:147]
    ds_read_b64_tr_b16 v[56:57], v17 offset:10240
    s_add_u32 m0, s46, 0
    v_mfma_f32_16x16x32_bf16 v[164:167], v[40:43], v[80:83], v[164:167]
    buffer_load_dwordx4 v8, s[48:51], s43 offen lds
    ds_read_b64_tr_b16 v[58:59], v17 offset:11520
    v_mfma_f32_16x16x32_bf16 v[184:187], v[40:43], v[84:87], v[184:187]
    v_mfma_f32_16x16x32_bf16 v[204:207], v[40:43], v[88:91], v[204:207]
    ds_read_b64_tr_b16 v[60:61], v18 offset:10240
    s_add_u32 m0, s47, 0
    v_mfma_f32_16x16x32_bf16 v[156:159], v[52:55], v[76:79], v[156:159]
    buffer_load_dwordx4 v12, s[52:55], s44 offen lds
    ds_read_b64_tr_b16 v[62:63], v18 offset:11520
    v_mfma_f32_16x16x32_bf16 v[176:179], v[52:55], v[80:83], v[176:179]
    ds_read_b64_tr_b16 v[72:73], v21 offset:10240
    v_mfma_f32_16x16x32_bf16 v[196:199], v[52:55], v[84:87], v[196:199]
    s_add_u32 m0, s46, 4096
    v_mfma_f32_16x16x32_bf16 v[216:219], v[52:55], v[88:91], v[216:219]
    buffer_load_dwordx4 v9, s[48:51], s43 offen lds
    ds_read_b64_tr_b16 v[74:75], v21 offset:11520
    v_mfma_f32_16x16x32_bf16 v[148:151], v[44:47], v[76:79], v[148:151]
    ds_read_b64_tr_b16 v[64:65], v19 offset:10240
    v_mfma_f32_16x16x32_bf16 v[168:171], v[44:47], v[80:83], v[168:171]
    s_add_u32 m0, s47, 4096
    v_mfma_f32_16x16x32_bf16 v[188:191], v[44:47], v[84:87], v[188:191]
    buffer_load_dwordx4 v13, s[52:55], s44 offen lds
    ds_read_b64_tr_b16 v[66:67], v19 offset:11520
    v_mfma_f32_16x16x32_bf16 v[208:211], v[44:47], v[88:91], v[208:211]
    ds_read_b64_tr_b16 v[68:69], v20 offset:10240
    v_mfma_f32_16x16x32_bf16 v[152:155], v[48:51], v[76:79], v[152:155]
    ds_read_b64_tr_b16 v[70:71], v20 offset:11520
    s_add_u32 m0, s46, 8192
    v_mfma_f32_16x16x32_bf16 v[172:175], v[48:51], v[80:83], v[172:175]
    buffer_load_dwordx4 v10, s[48:51], s43 offen lds
    v_mfma_f32_16x16x32_bf16 v[192:195], v[48:51], v[84:87], v[192:195]
    v_mfma_f32_16x16x32_bf16 v[212:215], v[48:51], v[88:91], v[212:215]
    s_waitcnt lgkmcnt(8)
    v_mfma_f32_16x16x32_bf16 v[140:143], v[56:59], v[92:95], v[140:143]
    v_mfma_f32_16x16x32_bf16 v[160:163], v[56:59], v[96:99], v[160:163]
    v_mfma_f32_16x16x32_bf16 v[180:183], v[56:59], v[100:103], v[180:183]
    v_mfma_f32_16x16x32_bf16 v[200:203], v[56:59], v[104:107], v[200:203]
    s_waitcnt vmcnt(7) lgkmcnt(0)
    s_barrier
    ds_read_b128 v[108:111], v2 offset:16384
    v_mfma_f32_16x16x32_bf16 v[144:147], v[60:63], v[92:95], v[144:147]
    ds_read_b128 v[112:115], v2 offset:18432
    s_add_u32 m0, s47, 8192
    v_mfma_f32_16x16x32_bf16 v[164:167], v[60:63], v[96:99], v[164:167]
    buffer_load_dwordx4 v14, s[52:55], s44 offen lds
    ds_read_b128 v[116:119], v2 offset:20480
    v_mfma_f32_16x16x32_bf16 v[184:187], v[60:63], v[100:103], v[184:187]
    ds_read_b128 v[120:123], v2 offset:22528
    ds_read_b64_tr_b16 v[36:37], v17 offset:20480
    v_mfma_f32_16x16x32_bf16 v[204:207], v[60:63], v[104:107], v[204:207]
    ds_read_b64_tr_b16 v[38:39], v17 offset:21760
    v_mfma_f32_16x16x32_bf16 v[156:159], v[72:75], v[92:95], v[156:159]
    ds_read_b64_tr_b16 v[40:41], v18 offset:20480
    s_add_u32 m0, s46, 12288
    v_mfma_f32_16x16x32_bf16 v[176:179], v[72:75], v[96:99], v[176:179]
    buffer_load_dwordx4 v11, s[48:51], s43 offen lds
    ds_read_b64_tr_b16 v[42:43], v18 offset:21760
    ds_read_b64_tr_b16 v[52:53], v21 offset:20480
    v_mfma_f32_16x16x32_bf16 v[196:199], v[72:75], v[100:103], v[196:199]
    ds_read_b64_tr_b16 v[54:55], v21 offset:21760
    v_mfma_f32_16x16x32_bf16 v[216:219], v[72:75], v[104:107], v[216:219]
    ds_read_b64_tr_b16 v[44:45], v19 offset:20480
    v_mfma_f32_16x16x32_bf16 v[148:151], v[64:67], v[92:95], v[148:151]
    ds_read_b64_tr_b16 v[46:47], v19 offset:21760
    s_add_u32 m0, s47, 12288
    v_mfma_f32_16x16x32_bf16 v[168:171], v[64:67], v[96:99], v[168:171]
    buffer_load_dwordx4 v15, s[52:55], s44 offen lds
    ds_read_b64_tr_b16 v[48:49], v20 offset:20480
    ds_read_b64_tr_b16 v[50:51], v20 offset:21760
    v_mfma_f32_16x16x32_bf16 v[188:191], v[64:67], v[100:103], v[188:191]
    ds_read_b128 v[124:127], v3 offset:16384
    v_mfma_f32_16x16x32_bf16 v[208:211], v[64:67], v[104:107], v[208:211]
    ds_read_b128 v[128:131], v3 offset:18432
    v_mfma_f32_16x16x32_bf16 v[152:155], v[68:71], v[92:95], v[152:155]
    ds_read_b128 v[132:135], v3 offset:20480
    ds_read_b128 v[136:139], v3 offset:22528
    s_add_u32 m0, s47, 16384
    v_mfma_f32_16x16x32_bf16 v[172:175], v[68:71], v[96:99], v[172:175]
    buffer_load_dwordx4 v16, s[52:55], s44 offen lds
    s_and_b32 s44, s64, 15
    s_lshr_b64 s[64:65], s[64:65], 4
    s_lshl_b32 s43, s44, 7
    s_mul_i32 s44, s44, 245760
    v_mfma_f32_16x16x32_bf16 v[192:195], v[68:71], v[100:103], v[192:195]
    v_mfma_f32_16x16x32_bf16 v[212:215], v[68:71], v[104:107], v[212:215]
Q_mid:
    s_waitcnt lgkmcnt(12)
    v_mfma_f32_16x16x32_bf16 v[140:143], v[36:39], v[108:111], v[140:143]
    v_mfma_f32_16x16x32_bf16 v[160:163], v[36:39], v[112:115], v[160:163]
    v_mfma_f32_16x16x32_bf16 v[180:183], v[36:39], v[116:119], v[180:183]
    v_mfma_f32_16x16x32_bf16 v[200:203], v[36:39], v[120:123], v[200:203]
    s_waitcnt vmcnt(9) lgkmcnt(0)
    s_barrier
    v_mfma_f32_16x16x32_bf16 v[144:147], v[40:43], v[108:111], v[144:147]
    ds_read_b64_tr_b16 v[56:57], v17 offset:30720
    s_add_u32 m0, s46, 16384
    v_mfma_f32_16x16x32_bf16 v[164:167], v[40:43], v[112:115], v[164:167]
    buffer_load_dwordx4 v8, s[48:51], s43 offen lds
    ds_read_b64_tr_b16 v[58:59], v17 offset:32000
    v_mfma_f32_16x16x32_bf16 v[184:187], v[40:43], v[116:119], v[184:187]
    v_mfma_f32_16x16x32_bf16 v[204:207], v[40:43], v[120:123], v[204:207]
    ds_read_b64_tr_b16 v[60:61], v18 offset:30720
    s_add_u32 m0, s47, 20480
    v_mfma_f32_16x16x32_bf16 v[156:159], v[52:55], v[108:111], v[156:159]
    buffer_load_dwordx4 v12, s[52:55], s44 offen lds
    ds_read_b64_tr_b16 v[62:63], v18 offset:32000
    v_mfma_f32_16x16x32_bf16 v[176:179], v[52:55], v[112:115], v[176:179]
    ds_read_b64_tr_b16 v[72:73], v21 offset:30720
    v_mfma_f32_16x16x32_bf16 v[196:199], v[52:55], v[116:119], v[196:199]
    s_add_u32 m0, s46, 20480
    v_mfma_f32_16x16x32_bf16 v[216:219], v[52:55], v[120:123], v[216:219]
    buffer_load_dwordx4 v9, s[48:51], s43 offen lds
    ds_read_b64_tr_b16 v[74:75], v21 offset:32000
    v_mfma_f32_16x16x32_bf16 v[148:151], v[44:47], v[108:111], v[148:151]
    ds_read_b64_tr_b16 v[64:65], v19 offset:30720
    v_mfma_f32_16x16x32_bf16 v[168:171], v[44:47], v[112:115], v[168:171]
    s_add_u32 m0, s47, 24576
    v_mfma_f32_16x16x32_bf16 v[188:191], v[44:47], v[116:119], v[188:191]
    buffer_load_dwordx4 v13, s[52:55], s44 offen lds
    ds_read_b64_tr_b16 v[66:67], v19 offset:32000
    v_mfma_f32_16x16x32_bf16 v[208:211], v[44:47], v[120:123], v[208:211]
    ds_read_b64_tr_b16 v[68:69], v20 offset:30720
    v_mfma_f32_16x16x32_bf16 v[152:155], v[48:51], v[108:111], v[152:155]
    ds_read_b64_tr_b16 v[70:71], v20 offset:32000
    s_add_u32 m0, s46, 24576
    v_mfma_f32_16x16x32_bf16 v[172:175], v[48:51], v[112:115], v[172:175]
    buffer_load_dwordx4 v10, s[48:51], s43 offen lds
    v_mfma_f32_16x16x32_bf16 v[192:195], v[48:51], v[116:119], v[192:195]
    v_mfma_f32_16x16x32_bf16 v[212:215], v[48:51], v[120:123], v[212:215]
    s_waitcnt lgkmcnt(8)
    v_mfma_f32_16x16x32_bf16 v[140:143], v[56:59], v[124:127], v[140:143]
    v_mfma_f32_16x16x32_bf16 v[160:163], v[56:59], v[128:131], v[160:163]
    v_mfma_f32_16x16x32_bf16 v[180:183], v[56:59], v[132:135], v[180:183]
    v_mfma_f32_16x16x32_bf16 v[200:203], v[56:59], v[136:139], v[200:203]
    s_waitcnt vmcnt(7) lgkmcnt(0)
    s_barrier
    ds_read_b128 v[76:79], v2 offset:0
    v_mfma_f32_16x16x32_bf16 v[144:147], v[60:63], v[124:127], v[144:147]
    ds_read_b128 v[80:83], v2 offset:2048
    s_add_u32 m0, s47, 28672
    v_mfma_f32_16x16x32_bf16 v[164:167], v[60:63], v[128:131], v[164:167]
    buffer_load_dwordx4 v14, s[52:55], s44 offen lds
    ds_read_b128 v[84:87], v2 offset:4096
    v_mfma_f32_16x16x32_bf16 v[184:187], v[60:63], v[132:135], v[184:187]
    ds_read_b128 v[88:91], v2 offset:6144
    ds_read_b64_tr_b16 v[36:37], v17 offset:0
    v_mfma_f32_16x16x32_bf16 v[204:207], v[60:63], v[136:139], v[204:207]
    ds_read_b64_tr_b16 v[38:39], v17 offset:1280
    v_mfma_f32_16x16x32_bf16 v[156:159], v[72:75], v[124:127], v[156:159]
    ds_read_b64_tr_b16 v[40:41], v18 offset:0
    s_add_u32 m0, s46, 28672
    v_mfma_f32_16x16x32_bf16 v[176:179], v[72:75], v[128:131], v[176:179]
    buffer_load_dwordx4 v11, s[48:51], s43 offen lds
    ds_read_b64_tr_b16 v[42:43], v18 offset:1280
    ds_read_b64_tr_b16 v[52:53], v21 offset:0
    v_mfma_f32_16x16x32_bf16 v[196:199], v[72:75], v[132:135], v[196:199]
    ds_read_b64_tr_b16 v[54:55], v21 offset:1280
    v_mfma_f32_16x16x32_bf16 v[216:219], v[72:75], v[136:139], v[216:219]
    ds_read_b64_tr_b16 v[44:45], v19 offset:0
    v_mfma_f32_16x16x32_bf16 v[148:151], v[64:67], v[124:127], v[148:151]
    ds_read_b64_tr_b16 v[46:47], v19 offset:1280
    s_add_u32 m0, s47, 32768
    v_mfma_f32_16x16x32_bf16 v[168:171], v[64:67], v[128:131], v[168:171]
    buffer_load_dwordx4 v15, s[52:55], s44 offen lds
    ds_read_b64_tr_b16 v[48:49], v20 offset:0
    ds_read_b64_tr_b16 v[50:51], v20 offset:1280
    v_mfma_f32_16x16x32_bf16 v[188:191], v[64:67], v[132:135], v[188:191]
    ds_read_b128 v[92:95], v3 offset:0
    v_mfma_f32_16x16x32_bf16 v[208:211], v[64:67], v[136:139], v[208:211]
    ds_read_b128 v[96:99], v3 offset:2048
    v_mfma_f32_16x16x32_bf16 v[152:155], v[68:71], v[124:127], v[152:155]
    ds_read_b128 v[100:103], v3 offset:4096
    ds_read_b128 v[104:107], v3 offset:6144
    s_add_u32 m0, s47, 36864
    v_mfma_f32_16x16x32_bf16 v[172:175], v[68:71], v[128:131], v[172:175]
    buffer_load_dwordx4 v16, s[52:55], s44 offen lds
    s_and_b32 s44, s64, 15
    s_lshr_b64 s[64:65], s[64:65], 4
    s_lshl_b32 s43, s44, 7
    s_mul_i32 s44, s44, 245760
    v_mfma_f32_16x16x32_bf16 v[192:195], v[68:71], v[132:135], v[192:195]
    v_mfma_f32_16x16x32_bf16 v[212:215], v[68:71], v[136:139], v[212:215]
    s_sub_u32 s45, s45, 1
    s_cmp_lg_u32 s45, 0
    s_cbranch_scc1 Q_loop
    v_mov_b32 v8, -1
    v_mov_b32 v9, -1
    v_mov_b32 v10, -1
    v_mov_b32 v11, -1
    s_mov_b64 exec, 1
    global_atomic_add v4, v5, s[38:39] sc1
    s_mov_b64 exec, -1
    s_waitcnt lgkmcnt(12)
    v_mfma_f32_16x16x32_bf16 v[140:143], v[36:39], v[76:79], v[140:143]
    v_mfma_f32_16x16x32_bf16 v[160:163], v[36:39], v[80:83], v[160:163]
    v_mfma_f32_16x16x32_bf16 v[180:183], v[36:39], v[84:87], v[180:183]
    v_mfma_f32_16x16x32_bf16 v[200:203], v[36:39], v[88:91], v[200:203]
    s_waitcnt vmcnt(10) lgkmcnt(0)
    s_barrier
    v_mfma_f32_16x16x32_bf16 v[144:147], v[40:43], v[76:79], v[144:147]
    ds_read_b64_tr_b16 v[56:57], v17 offset:10240
    s_nop 0
    v_mfma_f32_16x16x32_bf16 v[164:167], v[40:43], v[80:83], v[164:167]
    global_store_dwordx4 v236, v[8:11], s[38:39] offset:0 sc1
    ds_read_b64_tr_b16 v[58:59], v17 offset:11520
    v_mfma_f32_16x16x32_bf16 v[184:187], v[40:43], v[84:87], v[184:187]
    v_mfma_f32_16x16x32_bf16 v[204:207], v[40:43], v[88:91], v[204:207]
    ds_read_b64_tr_b16 v[60:61], v18 offset:10240
    v_mfma_f32_16x16x32_bf16 v[156:159], v[52:55], v[76:79], v[156:159]
    ds_read_b64_tr_b16 v[62:63], v18 offset:11520
    v_mfma_f32_16x16x32_bf16 v[176:179], v[52:55], v[80:83], v[176:179]
    ds_read_b64_tr_b16 v[72:73], v21 offset:10240
    v_mfma_f32_16x16x32_bf16 v[196:199], v[52:55], v[84:87], v[196:199]
    v_mfma_f32_16x16x32_bf16 v[216:219], v[52:55], v[88:91], v[216:219]
    ds_read_b64_tr_b16 v[74:75], v21 offset:11520
    v_mfma_f32_16x16x32_bf16 v[148:151], v[44:47], v[76:79], v[148:151]
    ds_read_b64_tr_b16 v[64:65], v19 offset:10240
    v_mfma_f32_16x16x32_bf16 v[168:171], v[44:47], v[80:83], v[168:171]
    v_mfma_f32_16x16x32_bf16 v[188:191], v[44:47], v[84:87], v[188:191]
    ds_read_b64_tr_b16 v[66:67], v19 offset:11520
    v_mfma_f32_16x16x32_bf16 v[208:211], v[44:47], v[88:91], v[208:211]
    ds_read_b64_tr_b16 v[68:69], v20 offset:10240
    v_mfma_f32_16x16x32_bf16 v[152:155], v[48:51], v[76:79], v[152:155]
    ds_read_b64_tr_b16 v[70:71], v20 offset:11520
    v_mfma_f32_16x16x32_bf16 v[172:175], v[48:51], v[80:83], v[172:175]
    v_mfma_f32_16x16x32_bf16 v[192:195], v[48:51], v[84:87], v[192:195]
    v_mfma_f32_16x16x32_bf16 v[212:215], v[48:51], v[88:91], v[212:215]
    s_waitcnt lgkmcnt(8)
    v_mfma_f32_16x16x32_bf16 v[140:143], v[56:59], v[92:95], v[140:143]
    v_mfma_f32_16x16x32_bf16 v[160:163], v[56:59], v[96:99], v[160:163]
    v_mfma_f32_16x16x32_bf16 v[180:183], v[56:59], v[100:103], v[180:183]
    v_mfma_f32_16x16x32_bf16 v[200:203], v[56:59], v[104:107], v[200:203]
    s_waitcnt vmcnt(4) lgkmcnt(0)
    s_barrier
    ds_read_b128 v[108:111], v2 offset:16384
    v_mfma_f32_16x16x32_bf16 v[144:147], v[60:63], v[92:95], v[144:147]
    ds_read_b128 v[112:115], v2 offset:18432
    s_nop 0
    v_mfma_f32_16x16x32_bf16 v[164:167], v[60:63], v[96:99], v[164:167]
    global_store_dwordx4 v236, v[8:11], s[38:39] offset:1024 sc1
    ds_read_b128 v[116:119], v2 offset:20480
    v_mfma_f32_16x16x32_bf16 v[184:187], v[60:63], v[100:103], v[184:187]
    ds_read_b128 v[120:123], v2 offset:22528
    ds_read_b64_tr_b16 v[36:37], v17 offset:20480
    v_mfma_f32_16x16x32_bf16 v[204:207], v[60:63], v[104:107], v[204:207]
    ds_read_b64_tr_b16 v[38:39], v17 offset:21760
    v_mfma_f32_16x16x32_bf16 v[156:159], v[72:75], v[92:95], v[156:159]
    ds_read_b64_tr_b16 v[40:41], v18 offset:20480
    v_mfma_f32_16x16x32_bf16 v[176:179], v[72:75], v[96:99], v[176:179]
    ds_read_b64_tr_b16 v[42:43], v18 offset:21760
    ds_read_b64_tr_b16 v[52:53], v21 offset:20480
    v_mfma_f32_16x16x32_bf16 v[196:199], v[72:75], v[100:103], v[196:199]
    ds_read_b64_tr_b16 v[54:55], v21 offset:21760
    v_mfma_f32_16x16x32_bf16 v[216:219], v[72:75], v[104:107], v[216:219]
    ds_read_b64_tr_b16 v[44:45], v19 offset:20480
    v_mfma_f32_16x16x32_bf16 v[148:151], v[64:67], v[92:95], v[148:151]
    ds_read_b64_tr_b16 v[46:47], v19 offset:21760
    v_mfma_f32_16x16x32_bf16 v[168:171], v[64:67], v[96:99], v[168:171]
    ds_read_b64_tr_b16 v[48:49], v20 offset:20480
    ds_read_b64_tr_b16 v[50:51], v20 offset:21760
    v_mfma_f32_16x16x32_bf16 v[188:191], v[64:67], v[100:103], v[188:191]
    ds_read_b128 v[124:127], v3 offset:16384
    v_mfma_f32_16x16x32_bf16 v[208:211], v[64:67], v[104:107], v[208:211]
    ds_read_b128 v[128:131], v3 offset:18432
    v_mfma_f32_16x16x32_bf16 v[152:155], v[68:71], v[92:95], v[152:155]
    ds_read_b128 v[132:135], v3 offset:20480
    ds_read_b128 v[136:139], v3 offset:22528
    v_mfma_f32_16x16x32_bf16 v[172:175], v[68:71], v[96:99], v[172:175]
    v_mfma_f32_16x16x32_bf16 v[192:195], v[68:71], v[100:103], v[192:195]
    v_mfma_f32_16x16x32_bf16 v[212:215], v[68:71], v[104:107], v[212:215]
    global_load_dword v7, v6, s[36:37] sc1
    s_waitcnt lgkmcnt(12)
    v_mfma_f32_16x16x32_bf16 v[140:143], v[36:39], v[108:111], v[140:143]
    v_mfma_f32_16x16x32_bf16 v[160:163], v[36:39], v[112:115], v[160:163]
    v_mfma_f32_16x16x32_bf16 v[180:183], v[36:39], v[116:119], v[180:183]
    v_mfma_f32_16x16x32_bf16 v[200:203], v[36:39], v[120:123], v[200:203]
    s_waitcnt vmcnt(4) lgkmcnt(0)
    s_barrier
    v_mfma_f32_16x16x32_bf16 v[144:147], v[40:43], v[108:111], v[144:147]
    ds_read_b64_tr_b16 v[56:57], v17 offset:30720
    s_nop 0
    v_mfma_f32_16x16x32_bf16 v[164:167], v[40:43], v[112:115], v[164:167]
    global_store_dwordx4 v237, v[8:11], s[38:39] offset:0 sc1
    ds_read_b64_tr_b16 v[58:59], v17 offset:32000
    v_mfma_f32_16x16x32_bf16 v[184:187], v[40:43], v[116:119], v[184:187]
    v_mfma_f32_16x16x32_bf16 v[204:207], v[40:43], v[120:123], v[204:207]
    ds_read_b64_tr_b16 v[60:61], v18 offset:30720
    v_mfma_f32_16x16x32_bf16 v[156:159], v[52:55], v[108:111], v[156:159]
    ds_read_b64_tr_b16 v[62:63], v18 offset:32000
    v_mfma_f32_16x16x32_bf16 v[176:179], v[52:55], v[112:115], v[176:179]
    ds_read_b64_tr_b16 v[72:73], v21 offset:30720
    v_mfma_f32_16x16x32_bf16 v[196:199], v[52:55], v[116:119], v[196:199]
    v_mfma_f32_16x16x32_bf16 v[216:219], v[52:55], v[120:123], v[216:219]
    ds_read_b64_tr_b16 v[74:75], v21 offset:32000
    v_mfma_f32_16x16x32_bf16 v[148:151], v[44:47], v[108:111], v[148:151]
    ds_read_b64_tr_b16 v[64:65], v19 offset:30720
    v_mfma_f32_16x16x32_bf16 v[168:171], v[44:47], v[112:115], v[168:171]
    v_mfma_f32_16x16x32_bf16 v[188:191], v[44:47], v[116:119], v[188:191]
    ds_read_b64_tr_b16 v[66:67], v19 offset:32000
    v_mfma_f32_16x16x32_bf16 v[208:211], v[44:47], v[120:123], v[208:211]
    ds_read_b64_tr_b16 v[68:69], v20 offset:30720
    v_mfma_f32_16x16x32_bf16 v[152:155], v[48:51], v[108:111], v[152:155]
    ds_read_b64_tr_b16 v[70:71], v20 offset:32000
    v_mfma_f32_16x16x32_bf16 v[172:175], v[48:51], v[112:115], v[172:175]
    v_mfma_f32_16x16x32_bf16 v[192:195], v[48:51], v[116:119], v[192:195]
    v_mfma_f32_16x16x32_bf16 v[212:215], v[48:51], v[120:123], v[212:215]
    s_waitcnt lgkmcnt(8)
    v_mfma_f32_16x16x32_bf16 v[140:143], v[56:59], v[124:127], v[140:143]
    v_mfma_f32_16x16x32_bf16 v[160:163], v[56:59], v[128:131], v[160:163]
    v_mfma_f32_16x16x32_bf16 v[180:183], v[56:59], v[132:135], v[180:183]
    v_mfma_f32_16x16x32_bf16 v[200:203], v[56:59], v[136:139], v[200:203]
    s_waitcnt lgkmcnt(0)
    v_mfma_f32_16x16x32_bf16 v[144:147], v[60:63], v[124:127], v[144:147]
    s_nop 0
    v_mfma_f32_16x16x32_bf16 v[164:167], v[60:63], v[128:131], v[164:167]
    global_store_dwordx4 v237, v[8:11], s[38:39] offset:1024 sc1
    v_mfma_f32_16x16x32_bf16 v[184:187], v[60:63], v[132:135], v[184:187]
    v_mfma_f32_16x16x32_bf16 v[204:207], v[60:63], v[136:139], v[204:207]
    v_mfma_f32_16x16x32_bf16 v[156:159], v[72:75], v[124:127], v[156:159]
    v_mfma_f32_16x16x32_bf16 v[176:179], v[72:75], v[128:131], v[176:179]
    v_mfma_f32_16x16x32_bf16 v[196:199], v[72:75], v[132:135], v[196:199]
    v_mfma_f32_16x16x32_bf16 v[216:219], v[72:75], v[136:139], v[216:219]
    v_mfma_f32_16x16x32_bf16 v[148:151], v[64:67], v[124:127], v[148:151]
    v_mfma_f32_16x16x32_bf16 v[168:171], v[64:67], v[128:131], v[168:171]
    v_mfma_f32_16x16x32_bf16 v[188:191], v[64:67], v[132:135], v[188:191]
    v_mfma_f32_16x16x32_bf16 v[208:211], v[64:67], v[136:139], v[208:211]
    v_mfma_f32_16x16x32_bf16 v[152:155], v[68:71], v[124:127], v[152:155]
    v_mfma_f32_16x16x32_bf16 v[172:175], v[68:71], v[128:131], v[172:175]
    v_mfma_f32_16x16x32_bf16 v[192:195], v[68:71], v[132:135], v[192:195]
    v_mfma_f32_16x16x32_bf16 v[212:215], v[68:71], v[136:139], v[212:215]
    v_mov_b32 v20, -1
    v_mov_b32 v21, -1
    v_mov_b32 v22, -1
    v_mov_b32 v23, -1
    s_mov_b32 s48, s38
    s_and_b32 s49, s39, 0xffff
    s_mov_b32 s50, 12582912
    s_mov_b32 s51, 0x20000
    s_mov_b32 s44, 0xffff0000
    s_mov_b32 s45, 0xffff0000
    s_mov_b32 s46, 0
    s_mov_b32 s47, -1
    s_mul_i32 s43, s4, 13568
    s_add_u32 s43, s43, 6356992
    global_store_dwordx4 v238, v[20:23], s[38:39] offset:0 sc1
    v_mul_f32 v24, s60, v140
    v_mul_f32 v25, s61, v141
    v_mul_f32 v26, s60, v142
    v_mul_f32 v27, s61, v143
    v_exp_f32 v24, v24 clamp
    v_exp_f32 v25, v25 clamp
    v_exp_f32 v26, v26 clamp
    v_exp_f32 v27, v27 clamp
    v_max_f32 v140, s62, v140
    v_max_f32 v141, s62, v141
    v_max_f32 v142, s62, v142
    v_max_f32 v143, s62, v143
    v_add_f32 v24, v24, v140
    v_add_f32 v25, v25, v141
    v_add_f32 v26, v26, v142
    v_add_f32 v27, v27, v143
    v_cvt_pk_bf16_f32 v36, v24, v25
    v_cvt_pk_bf16_f32 v37, v26, v27
    v_mul_f32 v28, s60, v156
    v_mul_f32 v29, s61, v157
    v_mul_f32 v30, s60, v158
    v_mul_f32 v31, s61, v159
    v_exp_f32 v28, v28 clamp
    v_exp_f32 v29, v29 clamp
    v_exp_f32 v30, v30 clamp
    v_exp_f32 v31, v31 clamp
    v_max_f32 v156, s62, v156
    v_max_f32 v157, s62, v157
    v_max_f32 v158, s62, v158
    v_max_f32 v159, s62, v159
    v_add_f32 v28, v28, v156
    v_add_f32 v29, v29, v157
    v_add_f32 v30, v30, v158
    v_add_f32 v31, v31, v159
    v_cvt_pk_bf16_f32 v38, v28, v29
    v_cvt_pk_bf16_f32 v39, v30, v31
    global_store_dwordx4 v238, v[20:23], s[38:39] offset:1024 sc1
    v_mul_f32 v24, s60, v144
    v_mul_f32 v25, s61, v145
    v_mul_f32 v26, s60, v146
    v_mul_f32 v27, s61, v147
    v_exp_f32 v24, v24 clamp
    v_exp_f32 v25, v25 clamp
    v_exp_f32 v26, v26 clamp
    v_exp_f32 v27, v27 clamp
    v_max_f32 v144, s62, v144
    v_max_f32 v145, s62, v145
    v_max_f32 v146, s62, v146
    v_max_f32 v147, s62, v147
    v_add_f32 v24, v24, v144
    v_add_f32 v25, v25, v145
    v_add_f32 v26, v26, v146
    v_add_f32 v27, v27, v147
    v_cvt_pk_bf16_f32 v40, v24, v25
    v_cvt_pk_bf16_f32 v41, v26, v27
    v_mul_f32 v28, s60, v148
    v_mul_f32 v29, s61, v149
    v_mul_f32 v30, s60, v150
    v_mul_f32 v31, s61, v151
    v_exp_f32 v28, v28 clamp
    v_exp_f32 v29, v29 clamp
    v_exp_f32 v30, v30 clamp
    v_exp_f32 v31, v31 clamp
    v_max_f32 v148, s62, v148
    v_max_f32 v149, s62, v149
    v_max_f32 v150, s62, v150
    v_max_f32 v151, s62, v151
    v_add_f32 v28, v28, v148
    v_add_f32 v29, v29, v149
    v_add_f32 v30, v30, v150
    v_add_f32 v31, v31, v151
    v_cvt_pk_bf16_f32 v42, v28, v29
    v_cvt_pk_bf16_f32 v43, v30, v31
    v_mul_f32 v24, s60, v152
    v_mul_f32 v25, s61, v153
    v_mul_f32 v26, s60, v154
    v_mul_f32 v27, s61, v155
    v_exp_f32 v24, v24 clamp
    v_exp_f32 v25, v25 clamp
    v_exp_f32 v26, v26 clamp
    v_exp_f32 v27, v27 clamp
    v_max_f32 v152, s62, v152
    v_max_f32 v153, s62, v153
    v_max_f32 v154, s62, v154
    v_max_f32 v155, s62, v155
    v_add_f32 v24, v24, v152
    v_add_f32 v25, v25, v153
    v_add_f32 v26, v26, v154
    v_add_f32 v27, v27, v155
    v_cvt_pk_bf16_f32 v46, v24, v25
    v_cvt_pk_bf16_f32 v47, v26, v27
    v_mov_b32 v44, v38
    v_mov_b32 v45, v39
    global_store_dwordx4 v239, v[20:23], s[38:39] offset:0 sc1
    v_mul_f32 v24, s60, v160
    v_mul_f32 v25, s61, v161
    v_mul_f32 v26, s60, v162
    v_mul_f32 v27, s61, v163
    v_exp_f32 v24, v24 clamp
    v_exp_f32 v25, v25 clamp
    v_exp_f32 v26, v26 clamp
    v_exp_f32 v27, v27 clamp
    v_max_f32 v160, s62, v160
    v_max_f32 v161, s62, v161
    v_max_f32 v162, s62, v162
    v_max_f32 v163, s62, v163
    v_add_f32 v24, v24, v160
    v_add_f32 v25, v25, v161
    v_add_f32 v26, v26, v162
    v_add_f32 v27, v27, v163
    v_cvt_pk_bf16_f32 v48, v24, v25
    v_cvt_pk_bf16_f32 v49, v26, v27
    v_mul_f32 v28, s60, v176
    v_mul_f32 v29, s61, v177
    v_mul_f32 v30, s60, v178
    v_mul_f32 v31, s61, v179
    v_exp_f32 v28, v28 clamp
    v_exp_f32 v29, v29 clamp
    v_exp_f32 v30, v30 clamp
    v_exp_f32 v31, v31 clamp
    v_max_f32 v176, s62, v176
    v_max_f32 v177, s62, v177
    v_max_f32 v178, s62, v178
    v_max_f32 v179, s62, v179
    v_add_f32 v28, v28, v176
    v_add_f32 v29, v29, v177
    v_add_f32 v30, v30, v178
    v_add_f32 v31, v31, v179
    v_cvt_pk_bf16_f32 v50, v28, v29
    v_cvt_pk_bf16_f32 v51, v30, v31
    global_store_dwordx4 v239, v[20:23], s[38:39] offset:1024 sc1
    v_mul_f32 v24, s60, v164
    v_mul_f32 v25, s61, v165
    v_mul_f32 v26, s60, v166
    v_mul_f32 v27, s61, v167
    v_exp_f32 v24, v24 clamp
    v_exp_f32 v25, v25 clamp
    v_exp_f32 v26, v26 clamp
    v_exp_f32 v27, v27 clamp
    v_max_f32 v164, s62, v164
    v_max_f32 v165, s62, v165
    v_max_f32 v166, s62, v166
    v_max_f32 v167, s62, v167
    v_add_f32 v24, v24, v164
    v_add_f32 v25, v25, v165
    v_add_f32 v26, v26, v166
    v_add_f32 v27, v27, v167
    v_cvt_pk_bf16_f32 v52, v24, v25
    v_cvt_pk_bf16_f32 v53, v26, v27
    v_mul_f32 v28, s60, v168
    v_mul_f32 v29, s61, v169
    v_mul_f32 v30, s60, v170
    v_mul_f32 v31, s61, v171
    v_exp_f32 v28, v28 clamp
    v_exp_f32 v29, v29 clamp
    v_exp_f32 v30, v30 clamp
    v_exp_f32 v31, v31 clamp
    v_max_f32 v168, s62, v168
    v_max_f32 v169, s62, v169
    v_max_f32 v170, s62, v170
    v_max_f32 v171, s62, v171
    v_add_f32 v28, v28, v168
    v_add_f32 v29, v29, v169
    v_add_f32 v30, v30, v170
    v_add_f32 v31, v31, v171
    v_cvt_pk_bf16_f32 v54, v28, v29
    v_cvt_pk_bf16_f32 v55, v30, v31
    v_mul_f32 v24, s60, v172
    v_mul_f32 v25, s61, v173
    v_mul_f32 v26, s60, v174
    v_mul_f32 v27, s61, v175
    v_exp_f32 v24, v24 clamp
    v_exp_f32 v25, v25 clamp
    v_exp_f32 v26, v26 clamp
    v_exp_f32 v27, v27 clamp
    v_max_f32 v172, s62, v172
    v_max_f32 v173, s62, v173
    v_max_f32 v174, s62, v174
    v_max_f32 v175, s62, v175
    v_add_f32 v24, v24, v172
    v_add_f32 v25, v25, v173
    v_add_f32 v26, v26, v174
    v_add_f32 v27, v27, v175
    v_cvt_pk_bf16_f32 v58, v24, v25
    v_cvt_pk_bf16_f32 v59, v26, v27
    v_mov_b32 v56, v50
    v_mov_b32 v57, v51
    global_store_dwordx4 v240, v[20:23], s[38:39] offset:0 sc1
    v_mul_f32 v24, s60, v180
    v_mul_f32 v25, s61, v181
    v_mul_f32 v26, s60, v182
    v_mul_f32 v27, s61, v183
    v_exp_f32 v24, v24 clamp
    v_exp_f32 v25, v25 clamp
    v_exp_f32 v26, v26 clamp
    v_exp_f32 v27, v27 clamp
    v_max_f32 v180, s62, v180
    v_max_f32 v181, s62, v181
    v_max_f32 v182, s62, v182
    v_max_f32 v183, s62, v183
    v_add_f32 v24, v24, v180
    v_add_f32 v25, v25, v181
    v_add_f32 v26, v26, v182
    v_add_f32 v27, v27, v183
    v_cvt_pk_bf16_f32 v60, v24, v25
    v_cvt_pk_bf16_f32 v61, v26, v27
    v_mul_f32 v28, s60, v196
    v_mul_f32 v29, s61, v197
    v_mul_f32 v30, s60, v198
    v_mul_f32 v31, s61, v199
    v_exp_f32 v28, v28 clamp
    v_exp_f32 v29, v29 clamp
    v_exp_f32 v30, v30 clamp
    v_exp_f32 v31, v31 clamp
    v_max_f32 v196, s62, v196
    v_max_f32 v197, s62, v197
    v_max_f32 v198, s62, v198
    v_max_f32 v199, s62, v199
    v_add_f32 v28, v28, v196
    v_add_f32 v29, v29, v197
    v_add_f32 v30, v30, v198
    v_add_f32 v31, v31, v199
    v_cvt_pk_bf16_f32 v62, v28, v29
    v_cvt_pk_bf16_f32 v63, v30, v31
    global_store_dwordx4 v241, v[20:23], s[38:39] offset:0 sc1
    v_mul_f32 v24, s60, v184
    v_mul_f32 v25, s61, v185
    v_mul_f32 v26, s60, v186
    v_mul_f32 v27, s61, v187
    v_exp_f32 v24, v24 clamp
    v_exp_f32 v25, v25 clamp
    v_exp_f32 v26, v26 clamp
    v_exp_f32 v27, v27 clamp
    v_max_f32 v184, s62, v184
    v_max_f32 v185, s62, v185
    v_max_f32 v186, s62, v186
    v_max_f32 v187, s62, v187
    v_add_f32 v24, v24, v184
    v_add_f32 v25, v25, v185
    v_add_f32 v26, v26, v186
    v_add_f32 v27, v27, v187
    v_cvt_pk_bf16_f32 v64, v24, v25
    v_cvt_pk_bf16_f32 v65, v26, v27
    v_mul_f32 v28, s60, v188
    v_mul_f32 v29, s61, v189
    v_mul_f32 v30, s60, v190
    v_mul_f32 v31, s61, v191
    v_exp_f32 v28, v28 clamp
    v_exp_f32 v29, v29 clamp
    v_exp_f32 v30, v30 clamp
    v_exp_f32 v31, v31 clamp
    v_max_f32 v188, s62, v188
    v_max_f32 v189, s62, v189
    v_max_f32 v190, s62, v190
    v_max_f32 v191, s62, v191
    v_add_f32 v28, v28, v188
    v_add_f32 v29, v29, v189
    v_add_f32 v30, v30, v190
    v_add_f32 v31, v31, v191
    v_cvt_pk_bf16_f32 v66, v28, v29
    v_cvt_pk_bf16_f32 v67, v30, v31
    v_mul_f32 v24, s60, v192
    v_mul_f32 v25, s61, v193
    v_mul_f32 v26, s60, v194
    v_mul_f32 v27, s61, v195
    v_exp_f32 v24, v24 clamp
    v_exp_f32 v25, v25 clamp
    v_exp_f32 v26, v26 clamp
    v_exp_f32 v27, v27 clamp
    v_max_f32 v192, s62, v192
    v_max_f32 v193, s62, v193
    v_max_f32 v194, s62, v194
    v_max_f32 v195, s62, v195
    v_add_f32 v24, v24, v192
    v_add_f32 v25, v25, v193
    v_add_f32 v26, v26, v194
    v_add_f32 v27, v27, v195
    v_cvt_pk_bf16_f32 v70, v24, v25
    v_cvt_pk_bf16_f32 v71, v26, v27
    v_mov_b32 v68, v62
    v_mov_b32 v69, v63
    v_mul_f32 v24, s60, v200
    v_mul_f32 v25, s61, v201
    v_mul_f32 v26, s60, v202
    v_mul_f32 v27, s61, v203
    v_exp_f32 v24, v24 clamp
    v_exp_f32 v25, v25 clamp
    v_exp_f32 v26, v26 clamp
    v_exp_f32 v27, v27 clamp
    v_max_f32 v200, s62, v200
    v_max_f32 v201, s62, v201
    v_max_f32 v202, s62, v202
    v_max_f32 v203, s62, v203
    v_add_f32 v24, v24, v200
    v_add_f32 v25, v25, v201
    v_add_f32 v26, v26, v202
    v_add_f32 v27, v27, v203
    v_cvt_pk_bf16_f32 v72, v24, v25
    v_cvt_pk_bf16_f32 v73, v26, v27
    v_mul_f32 v28, s60, v216
    v_mul_f32 v29, s61, v217
    v_mul_f32 v30, s60, v218
    v_mul_f32 v31, s61, v219
    v_exp_f32 v28, v28 clamp
    v_exp_f32 v29, v29 clamp
    v_exp_f32 v30, v30 clamp
    v_exp_f32 v31, v31 clamp
    v_max_f32 v216, s62, v216
    v_max_f32 v217, s62, v217
    v_max_f32 v218, s62, v218
    v_max_f32 v219, s62, v219
    v_add_f32 v28, v28, v216
    v_add_f32 v29, v29, v217
    v_add_f32 v30, v30, v218
    v_add_f32 v31, v31, v219
    v_cvt_pk_bf16_f32 v74, v28, v29
    v_cvt_pk_bf16_f32 v75, v30, v31
    v_mul_f32 v24, s60, v204
    v_mul_f32 v25, s61, v205
    v_mul_f32 v26, s60, v206
    v_mul_f32 v27, s61, v207
    v_exp_f32 v24, v24 clamp
    v_exp_f32 v25, v25 clamp
    v_exp_f32 v26, v26 clamp
    v_exp_f32 v27, v27 clamp
    v_max_f32 v204, s62, v204
    v_max_f32 v205, s62, v205
    v_max_f32 v206, s62, v206
    v_max_f32 v207, s62, v207
    v_add_f32 v24, v24, v204
    v_add_f32 v25, v25, v205
    v_add_f32 v26, v26, v206
    v_add_f32 v27, v27, v207
    v_cvt_pk_bf16_f32 v76, v24, v25
    v_cvt_pk_bf16_f32 v77, v26, v27
    v_mul_f32 v28, s60, v208
    v_mul_f32 v29, s61, v209
    v_mul_f32 v30, s60, v210
    v_mul_f32 v31, s61, v211
    v_exp_f32 v28, v28 clamp
    v_exp_f32 v29, v29 clamp
    v_exp_f32 v30, v30 clamp
    v_exp_f32 v31, v31 clamp
    v_max_f32 v208, s62, v208
    v_max_f32 v209, s62, v209
    v_max_f32 v210, s62, v210
    v_max_f32 v211, s62, v211
    v_add_f32 v28, v28, v208
    v_add_f32 v29, v29, v209
    v_add_f32 v30, v30, v210
    v_add_f32 v31, v31, v211
    v_cvt_pk_bf16_f32 v78, v28, v29
    v_cvt_pk_bf16_f32 v79, v30, v31
    v_mul_f32 v24, s60, v212
    v_mul_f32 v25, s61, v213
    v_mul_f32 v26, s60, v214
    v_mul_f32 v27, s61, v215
    v_exp_f32 v24, v24 clamp
    v_exp_f32 v25, v25 clamp
    v_exp_f32 v26, v26 clamp
    v_exp_f32 v27, v27 clamp
    v_max_f32 v212, s62, v212
    v_max_f32 v213, s62, v213
    v_max_f32 v214, s62, v214
    v_max_f32 v215, s62, v215
    v_add_f32 v24, v24, v212
    v_add_f32 v25, v25, v213
    v_add_f32 v26, v26, v214
    v_add_f32 v27, v27, v215
    v_cvt_pk_bf16_f32 v82, v24, v25
    v_cvt_pk_bf16_f32 v83, v26, v27
    v_mov_b32 v80, v74
    v_mov_b32 v81, v75
    v_mov_b32 v108, 0
    v_mov_b32 v109, 0
    v_mov_b32 v120, 0
    v_mov_b32 v121, 0
    v_mov_b32 v124, s62
    v_mov_b32 v125, s62
    v_mov_b32 v126, s62
    v_mov_b32 v127, s62
    v_mov_b32 v19, v228
    v_mov_b32 v8, v220
    v_mov_b32 v9, v221
    v_mov_b32 v10, v222
    v_mov_b32 v11, v223
    v_mov_b32 v12, v224
    v_mov_b32 v13, v225
    v_add_u32 v14, 128, v227
    v_mov_b32 v15, v229
    s_mov_b32 s41, 0
    s_mov_b32 s66, 300000
    s_branch poll2c
poll2:
    global_load_dword v7, v6, s[36:37] sc1
poll2c:
    s_waitcnt vmcnt(0)
    v_cmp_le_u32 vcc, 64, v7
    s_nop 0
    s_and_b32 vcc_lo, vcc_lo, 1
    s_cmp_eq_u32 vcc_lo, 1
    s_cbranch_scc1 poll2d
    s_sleep 2
    s_sub_u32 s66, s66, 1
    s_cmp_lg_u32 s66, 0
    s_cbranch_scc1 poll2
poll2d:
    s_cmp_lg_u32 s40, 0
    s_cbranch_scc1 Q_nopoll
    s_mov_b64 exec, 1
    s_mov_b32 m0, 0
    s_mov_b32 s66, 300000
poll3:
    global_load_dword v7, v227, s[38:39] sc1
poll3c:
    s_waitcnt vmcnt(0)
    v_cmp_le_u32 vcc, 32, v7
    s_nop 0
    s_and_b32 vcc_lo, vcc_lo, 1
    s_cmp_eq_u32 vcc_lo, 1
    s_cbranch_scc1 poll3d
    s_sleep 2
    s_sub_u32 s66, s66, 1
    s_cmp_lg_u32 s66, 0
    s_cbranch_scc1 poll3
poll3d:
    s_mov_b64 exec, -1
    buffer_load_dwordx4 v229, s[48:51], s43 offen sc1 lds
    buffer_load_dwordx4 v229, s[48:51], s43 offen offset:1024 sc1 lds
    buffer_load_dwordx4 v229, s[48:51], s43 offen offset:2048 sc1 lds
    buffer_load_dwordx4 v229, s[48:51], s43 offen offset:3072 sc1 lds
    s_mov_b32 m0, 4096
    s_add_u32 s58, s43, 4096
    buffer_load_dwordx4 v229, s[48:51], s58 offen sc1 lds
    buffer_load_dwordx4 v229, s[48:51], s58 offen offset:1024 sc1 lds
    buffer_load_dwordx4 v229, s[48:51], s58 offen offset:2048 sc1 lds
    s_mov_b32 m0, 6784
    s_add_u32 s58, s43, 6784
    buffer_load_dwordx4 v229, s[48:51], s58 offen sc1 lds
    buffer_load_dwordx4 v229, s[48:51], s58 offen offset:1024 sc1 lds
    buffer_load_dwordx4 v229, s[48:51], s58 offen offset:2048 sc1 lds
    buffer_load_dwordx4 v229, s[48:51], s58 offen offset:3072 sc1 lds
    s_mov_b32 m0, 10880
    s_add_u32 s58, s43, 10880
    buffer_load_dwordx4 v229, s[48:51], s58 offen sc1 lds
    buffer_load_dwordx4 v229, s[48:51], s58 offen offset:1024 sc1 lds
    buffer_load_dwordx4 v229, s[48:51], s58 offen offset:2048 sc1 lds
    s_waitcnt vmcnt(0)
Q_nopoll:
    s_barrier
Q_o:
    ds_read_b128 v[172:175], v13 offset:1600
    ds_read_b128 v[176:179], v12 offset:1664
    ds_read_b128 v[132:135], v9 offset:0
    ds_read_b128 v[136:139], v8 offset:64
    ds_read_b128 v[140:143], v9 offset:1680
    ds_read_b128 v[144:147], v8 offset:1744
    ds_read_b128 v[148:151], v9 offset:3360
    ds_read_b128 v[152:155], v8 offset:3424
    ds_read_b128 v[156:159], v9 offset:5040
    ds_read_b128 v[160:163], v8 offset:5104
    ds_read_b128 v[164:167], v11 offset:1280
    ds_read_b128 v[168:171], v10 offset:1344
    s_waitcnt lgkmcnt(10)
    v_cvt_pk_bf16_f32 v172, v172, v173
    v_cvt_pk_bf16_f32 v173, v174, v175
    v_cvt_pk_bf16_f32 v176, v176, v177
    v_cvt_pk_bf16_f32 v177, v178, v179
    v_and_b32 v100, v172, v246
    v_and_b32 v101, v173, v246
    v_and_b32 v102, v176, v254
    v_and_b32 v103, v177, v254
    v_and_b32 v104, v172, v247
    v_and_b32 v105, v173, v247
    v_and_b32 v106, v172, v248
    v_and_b32 v107, v173, v248
    v_and_b32 v110, v172, v249
    v_and_b32 v111, v173, v249
    v_mfma_f32_16x16x32_bf16 v[180:183], v[100:103], v[36:39], v[124:127]
    s_waitcnt lgkmcnt(8)
    v_cvt_pk_bf16_f32 v84, v132, v133
    v_cvt_pk_bf16_f32 v85, v134, v135
    v_cvt_pk_bf16_f32 v136, v136, v137
    v_mfma_f32_16x16x32_bf16 v[184:187], v[100:103], v[48:51], v[124:127]
    v_cvt_pk_bf16_f32 v137, v138, v139
    v_and_b32 v86, v136, v242
    v_and_b32 v87, v137, v242
    s_waitcnt lgkmcnt(6)
    v_cvt_pk_bf16_f32 v90, v140, v141
    v_mfma_f32_16x16x32_bf16 v[180:183], v[104:107], v[40:43], v[180:183]
    v_cvt_pk_bf16_f32 v91, v142, v143
    v_cvt_pk_bf16_f32 v144, v144, v145
    v_cvt_pk_bf16_f32 v145, v146, v147
    v_and_b32 v88, v144, v243
    v_and_b32 v89, v145, v243
    v_mfma_f32_16x16x32_bf16 v[184:187], v[104:107], v[52:55], v[184:187]
    s_waitcnt lgkmcnt(4)
    v_cvt_pk_bf16_f32 v92, v148, v149
    v_cvt_pk_bf16_f32 v93, v150, v151
    v_cvt_pk_bf16_f32 v152, v152, v153
    v_mfma_f32_16x16x32_bf16 v[180:183], v[108:111], v[44:47], v[180:183]
    v_cvt_pk_bf16_f32 v153, v154, v155
    v_and_b32 v94, v152, v244
    v_and_b32 v95, v153, v244
    s_waitcnt lgkmcnt(2)
    v_cvt_pk_bf16_f32 v98, v156, v157
    v_mfma_f32_16x16x32_bf16 v[184:187], v[108:111], v[56:59], v[184:187]
    v_cvt_pk_bf16_f32 v99, v158, v159
    v_cvt_pk_bf16_f32 v160, v160, v161
    v_cvt_pk_bf16_f32 v161, v162, v163
    v_and_b32 v96, v160, v245
    v_and_b32 v97, v161, v245
    s_waitcnt lgkmcnt(0)
    v_mfma_f32_16x16x32_bf16 v[196:199], v[84:87], v[36:39], 0
    v_cvt_pk_bf16_f32 v164, v164, v165
    v_cvt_pk_bf16_f32 v165, v166, v167
    v_mfma_f32_16x16x32_bf16 v[200:203], v[88:91], v[38:41], 0
    v_cvt_pk_bf16_f32 v168, v168, v169
    v_cvt_pk_bf16_f32 v169, v170, v171
    v_mfma_f32_16x16x32_bf16 v[204:207], v[92:95], v[42:45], 0
    v_and_b32 v112, v164, v250
    v_and_b32 v113, v165, v250
    v_mfma_f32_16x16x32_bf16 v[208:211], v[96:99], v[44:47], 0
    v_and_b32 v114, v168, v255
    v_and_b32 v115, v169, v255
    v_and_b32 v116, v164, v251
    v_mfma_f32_16x16x32_bf16 v[216:219], v[84:87], v[48:51], 0
    v_and_b32 v117, v165, v251
    v_and_b32 v118, v164, v252
    v_mfma_f32_16x16x32_bf16 v[220:223], v[88:91], v[50:53], 0
    v_and_b32 v119, v165, v252
    v_and_b32 v122, v164, v253
    v_mfma_f32_16x16x32_bf16 v[224:227], v[92:95], v[54:57], 0
    v_and_b32 v123, v165, v253
    v_rcp_f32 v180, v180
    v_mfma_f32_16x16x32_bf16 v[228:231], v[96:99], v[56:59], 0
    v_rcp_f32 v181, v181
    v_rcp_f32 v182, v182
    v_rcp_f32 v183, v183
    v_mfma_f32_16x16x32_bf16 v[212:215], v[112:115], v[36:39], 0
    v_mul_f32 v196, v196, v180
    v_mul_f32 v197, v197, v180
    v_mul_f32 v198, v198, v180
    v_mfma_f32_16x16x32_bf16 v[212:215], v[116:119], v[40:43], v[212:215]
    v_mul_f32 v199, v199, v180
    v_cvt_pk_bf16_f32 v132, v196, v197
    v_cvt_pk_bf16_f32 v133, v198, v199
    v_mfma_f32_16x16x32_bf16 v[212:215], v[120:123], v[44:47], v[212:215]
    v_mul_f32 v200, v200, v181
    v_mul_f32 v201, v201, v181
    v_mul_f32 v202, v202, v181
    v_mul_f32 v203, v203, v181
    v_mfma_f32_16x16x32_bf16 v[232:235], v[112:115], v[48:51], 0
    v_cvt_pk_bf16_f32 v134, v200, v201
    v_cvt_pk_bf16_f32 v135, v202, v203
    global_store_dwordx4 v236, v[132:135], s[38:39] offset:0 sc1
    v_mfma_f32_16x16x32_bf16 v[232:235], v[116:119], v[52:55], v[232:235]
    v_mul_f32 v204, v204, v182
    v_mul_f32 v205, v205, v182
    v_mul_f32 v206, v206, v182
    v_mfma_f32_16x16x32_bf16 v[232:235], v[120:123], v[56:59], v[232:235]
    v_mul_f32 v207, v207, v182
    v_cvt_pk_bf16_f32 v136, v204, v205
    v_cvt_pk_bf16_f32 v137, v206, v207
    v_mul_f32 v208, v208, v183
    v_mul_f32 v209, v209, v183
    v_mul_f32 v210, v210, v183
    v_mul_f32 v211, v211, v183
    v_cvt_pk_bf16_f32 v138, v208, v209
    v_cvt_pk_bf16_f32 v139, v210, v211
    global_store_dwordx4 v236, v[136:139], s[38:39] offset:1024 sc1
    v_cndmask_b32 v16, v180, v181, s[44:45]
    v_cndmask_b32 v17, v182, v183, s[44:45]
    v_cndmask_b32 v16, v16, v17, s[46:47]
    v_mul_f32 v212, v212, v16
    v_mul_f32 v213, v213, v16
    v_mul_f32 v214, v214, v16
    v_mul_f32 v215, v215, v16
    v_cvt_pk_bf16_f32 v20, v212, v213
    v_cvt_pk_bf16_f32 v21, v214, v215
    v_rcp_f32 v184, v184
    v_rcp_f32 v185, v185
    v_rcp_f32 v186, v186
    v_rcp_f32 v187, v187
    v_mul_f32 v216, v216, v184
    v_mul_f32 v217, v217, v184
    v_mul_f32 v218, v218, v184
    v_mul_f32 v219, v219, v184
    v_cvt_pk_bf16_f32 v140, v216, v217
    v_cvt_pk_bf16_f32 v141, v218, v219
    v_mul_f32 v220, v220, v185
    v_mul_f32 v221, v221, v185
    v_mul_f32 v222, v222, v185
    v_mul_f32 v223, v223, v185
    v_cvt_pk_bf16_f32 v142, v220, v221
    v_cvt_pk_bf16_f32 v143, v222, v223
    global_store_dwordx4 v237, v[140:143], s[38:39] offset:0 sc1
    v_mul_f32 v224, v224, v186
    v_mul_f32 v225, v225, v186
    v_mul_f32 v226, v226, v186
    v_mul_f32 v227, v227, v186
    v_cvt_pk_bf16_f32 v144, v224, v225
    v_cvt_pk_bf16_f32 v145, v226, v227
    v_mul_f32 v228, v228, v187
    v_mul_f32 v229, v229, v187
    v_mul_f32 v230, v230, v187
    v_mul_f32 v231, v231, v187
    v_cvt_pk_bf16_f32 v146, v228, v229
    v_cvt_pk_bf16_f32 v147, v230, v231
    global_store_dwordx4 v237, v[144:147], s[38:39] offset:1024 sc1
    v_cndmask_b32 v16, v184, v185, s[44:45]
    v_mfma_f32_16x16x32_bf16 v[188:191], v[100:103], v[60:63], v[124:127]
    v_cndmask_b32 v17, v186, v187, s[44:45]
    v_cndmask_b32 v16, v16, v17, s[46:47]
    v_mfma_f32_16x16x32_bf16 v[192:195], v[100:103], v[72:75], v[124:127]
    v_mul_f32 v232, v232, v16
    v_mul_f32 v233, v233, v16
    v_mfma_f32_16x16x32_bf16 v[188:191], v[104:107], v[64:67], v[188:191]
    v_mul_f32 v234, v234, v16
    v_mul_f32 v235, v235, v16
    v_mfma_f32_16x16x32_bf16 v[192:195], v[104:107], v[76:79], v[192:195]
    v_cvt_pk_bf16_f32 v22, v232, v233
    v_cvt_pk_bf16_f32 v23, v234, v235
    global_store_dwordx4 v240, v[20:23], s[38:39] sc1
    v_mov_b32 v2, 1
    s_mov_b64 exec, 31
    global_atomic_add v19, v2, s[38:39] sc1
    s_mov_b64 exec, -1
    v_mfma_f32_16x16x32_bf16 v[188:191], v[108:111], v[68:71], v[188:191]
    v_mfma_f32_16x16x32_bf16 v[192:195], v[108:111], v[80:83], v[192:195]
    v_mfma_f32_16x16x32_bf16 v[196:199], v[84:87], v[60:63], 0
    v_mfma_f32_16x16x32_bf16 v[200:203], v[88:91], v[62:65], 0
    v_mfma_f32_16x16x32_bf16 v[204:207], v[92:95], v[66:69], 0
    v_mfma_f32_16x16x32_bf16 v[208:211], v[96:99], v[68:71], 0
    v_mfma_f32_16x16x32_bf16 v[212:215], v[112:115], v[60:63], 0
    v_mfma_f32_16x16x32_bf16 v[212:215], v[116:119], v[64:67], v[212:215]
    v_mfma_f32_16x16x32_bf16 v[212:215], v[120:123], v[68:71], v[212:215]
    v_mfma_f32_16x16x32_bf16 v[216:219], v[84:87], v[72:75], 0
    v_mfma_f32_16x16x32_bf16 v[220:223], v[88:91], v[74:77], 0
    v_rcp_f32 v188, v188
    v_rcp_f32 v189, v189
    v_rcp_f32 v190, v190
    v_rcp_f32 v191, v191
    v_mfma_f32_16x16x32_bf16 v[224:227], v[92:95], v[78:81], 0
    v_mul_f32 v196, v196, v188
    v_mul_f32 v197, v197, v188
    v_mul_f32 v198, v198, v188
    v_mul_f32 v199, v199, v188
    v_cvt_pk_bf16_f32 v148, v196, v197
    v_mfma_f32_16x16x32_bf16 v[228:231], v[96:99], v[80:83], 0
    v_cvt_pk_bf16_f32 v149, v198, v199
    v_mul_f32 v200, v200, v189
    v_mul_f32 v201, v201, v189
    v_mul_f32 v202, v202, v189
    v_mul_f32 v203, v203, v189
    v_cvt_pk_bf16_f32 v150, v200, v201
    v_mfma_f32_16x16x32_bf16 v[232:235], v[112:115], v[72:75], 0
    v_cvt_pk_bf16_f32 v151, v202, v203
    global_store_dwordx4 v238, v[148:151], s[38:39] offset:0 sc1
    v_mul_f32 v204, v204, v190
    v_mul_f32 v205, v205, v190
    v_mul_f32 v206, v206, v190
    v_mfma_f32_16x16x32_bf16 v[232:235], v[116:119], v[76:79], v[232:235]
    v_mul_f32 v207, v207, v190
    v_cvt_pk_bf16_f32 v152, v204, v205
    v_cvt_pk_bf16_f32 v153, v206, v207
    v_mul_f32 v208, v208, v191
    v_mul_f32 v209, v209, v191
    v_mul_f32 v210, v210, v191
    v_mfma_f32_16x16x32_bf16 v[232:235], v[120:123], v[80:83], v[232:235]
    v_mul_f32 v211, v211, v191
    v_cvt_pk_bf16_f32 v154, v208, v209
    v_cvt_pk_bf16_f32 v155, v210, v211
    global_store_dwordx4 v238, v[152:155], s[38:39] offset:1024 sc1
    v_cndmask_b32 v16, v188, v189, s[44:45]
    v_cndmask_b32 v17, v190, v191, s[44:45]
    v_cndmask_b32 v16, v16, v17, s[46:47]
    v_mul_f32 v212, v212, v16
    v_mul_f32 v213, v213, v16
    v_mul_f32 v214, v214, v16
    v_mul_f32 v215, v215, v16
    v_cvt_pk_bf16_f32 v24, v212, v213
    v_cvt_pk_bf16_f32 v25, v214, v215
    v_rcp_f32 v192, v192
    v_rcp_f32 v193, v193
    v_rcp_f32 v194, v194
    v_rcp_f32 v195, v195
    v_mul_f32 v216, v216, v192
    v_mul_f32 v217, v217, v192
    v_mul_f32 v218, v218, v192
    v_mul_f32 v219, v219, v192
    v_cvt_pk_bf16_f32 v156, v216, v217
    v_cvt_pk_bf16_f32 v157, v218, v219
    v_mul_f32 v220, v220, v193
    v_mul_f32 v221, v221, v193
    v_mul_f32 v222, v222, v193
    v_mul_f32 v223, v223, v193
    v_cvt_pk_bf16_f32 v158, v220, v221
    v_cvt_pk_bf16_f32 v159, v222, v223
    global_store_dwordx4 v239, v[156:159], s[38:39] offset:0 sc1
    v_mul_f32 v224, v224, v194
    v_mul_f32 v225, v225, v194
    v_mul_f32 v226, v226, v194
    v_mul_f32 v227, v227, v194
    v_cvt_pk_bf16_f32 v160, v224, v225
    v_cvt_pk_bf16_f32 v161, v226, v227
    v_mul_f32 v228, v228, v195
    v_mul_f32 v229, v229, v195
    v_mul_f32 v230, v230, v195
    v_mul_f32 v231, v231, v195
    v_cvt_pk_bf16_f32 v162, v228, v229
    v_cvt_pk_bf16_f32 v163, v230, v231
    global_store_dwordx4 v239, v[160:163], s[38:39] offset:1024 sc1
    v_cndmask_b32 v16, v192, v193, s[44:45]
    v_cndmask_b32 v17, v194, v195, s[44:45]
    v_cndmask_b32 v16, v16, v17, s[46:47]
    v_mul_f32 v232, v232, v16
    v_mul_f32 v233, v233, v16
    v_mul_f32 v234, v234, v16
    v_mul_f32 v235, v235, v16
    v_cvt_pk_bf16_f32 v26, v232, v233
    v_cvt_pk_bf16_f32 v27, v234, v235
    global_store_dwordx4 v241, v[24:27], s[38:39] sc1
    s_cmp_lg_u32 s41, 0
    s_cbranch_scc1 Q_fin
    s_cmp_lg_u32 s40, 0
    s_cbranch_scc1 Q_nopoll2
    s_mov_b64 exec, 1
    s_mov_b32 s66, 300000
poll4:
    global_load_dword v7, v14, s[38:39] sc1
poll4c:
    s_waitcnt vmcnt(0)
    v_cmp_le_u32 vcc, 32, v7
    s_nop 0
    s_and_b32 vcc_lo, vcc_lo, 1
    s_cmp_eq_u32 vcc_lo, 1
    s_cbranch_scc1 poll4d
    s_sleep 4
    s_sub_u32 s66, s66, 1
    s_cmp_lg_u32 s66, 0
    s_cbranch_scc1 poll4
poll4d:
    s_mov_b64 exec, -1
    s_mov_b32 m0, 16384
    s_add_u32 s58, s43, 0
    buffer_load_dwordx4 v15, s[48:51], s58 offen sc1 lds
    buffer_load_dwordx4 v15, s[48:51], s58 offen offset:1024 sc1 lds
    buffer_load_dwordx4 v15, s[48:51], s58 offen offset:2048 sc1 lds
    buffer_load_dwordx4 v15, s[48:51], s58 offen offset:3072 sc1 lds
    s_mov_b32 m0, 20480
    s_add_u32 s58, s43, 4096
    buffer_load_dwordx4 v15, s[48:51], s58 offen sc1 lds
    buffer_load_dwordx4 v15, s[48:51], s58 offen offset:1024 sc1 lds
    buffer_load_dwordx4 v15, s[48:51], s58 offen offset:2048 sc1 lds
    s_mov_b32 m0, 23168
    s_add_u32 s58, s43, 6784
    buffer_load_dwordx4 v15, s[48:51], s58 offen sc1 lds
    buffer_load_dwordx4 v15, s[48:51], s58 offen offset:1024 sc1 lds
    buffer_load_dwordx4 v15, s[48:51], s58 offen offset:2048 sc1 lds
    buffer_load_dwordx4 v15, s[48:51], s58 offen offset:3072 sc1 lds
    s_mov_b32 m0, 27264
    s_add_u32 s58, s43, 10880
    buffer_load_dwordx4 v15, s[48:51], s58 offen sc1 lds
    buffer_load_dwordx4 v15, s[48:51], s58 offen offset:1024 sc1 lds
    buffer_load_dwordx4 v15, s[48:51], s58 offen offset:2048 sc1 lds
Q_nopoll2:
    v_add_u32 v3, 768, v0
    v_min_u32 v3, 843, v3
    v_lshlrev_b32 v3, 4, v3
    v_lshlrev_b32 v4, 4, v0
    s_lshl_b32 s42, s40, 2
    v_mov_b32 v5, s42
    v_mov_b32 v6, 0
    s_waitcnt vmcnt(0)
    s_barrier
    ds_read_b128 v[196:199], v4 offset:0
    ds_read_b128 v[200:203], v4 offset:16384
    ds_read_b128 v[204:207], v4 offset:4096
    ds_read_b128 v[208:211], v4 offset:20480
    ds_read_b128 v[212:215], v4 offset:8192
    ds_read_b128 v[216:219], v4 offset:24576
    ds_read_b128 v[220:223], v3 offset:0
    ds_read_b128 v[224:227], v3 offset:16384
    s_waitcnt lgkmcnt(6)
    v_xor_b32 v196, v196, v200
    v_xor_b32 v197, v197, v201
    v_xor_b32 v198, v198, v202
    v_xor_b32 v199, v199, v203
    v_or3_b32 v6, v6, v196, v197
    v_or3_b32 v6, v6, v198, v199
    s_waitcnt lgkmcnt(4)
    v_xor_b32 v204, v204, v208
    v_xor_b32 v205, v205, v209
    v_xor_b32 v206, v206, v210
    v_xor_b32 v207, v207, v211
    v_or3_b32 v6, v6, v204, v205
    v_or3_b32 v6, v6, v206, v207
    s_waitcnt lgkmcnt(2)
    v_xor_b32 v212, v212, v216
    v_xor_b32 v213, v213, v217
    v_xor_b32 v214, v214, v218
    v_xor_b32 v215, v215, v219
    v_or3_b32 v6, v6, v212, v213
    v_or3_b32 v6, v6, v214, v215
    s_waitcnt lgkmcnt(0)
    v_xor_b32 v220, v220, v224
    v_xor_b32 v221, v221, v225
    v_xor_b32 v222, v222, v226
    v_xor_b32 v223, v223, v227
    v_or3_b32 v6, v6, v220, v221
    v_or3_b32 v6, v6, v222, v223
    v_cmp_ne_u32 vcc, 0, v6
    s_nop 0
    s_or_b32 s42, vcc_lo, vcc_hi
    v_mov_b32 v6, s42
    v_mov_b32 v7, 0
    ds_write_b32 v5, v6 offset:32000
    s_waitcnt lgkmcnt(0)
    s_barrier
    ds_read_b128 v[196:199], v7 offset:32000
    s_waitcnt lgkmcnt(0)
    v_or3_b32 v6, v196, v197, v198
    v_or_b32 v6, v6, v199
    s_nop 0
    v_readfirstlane_b32 s41, v6
    s_nop 0
    s_cmp_eq_u32 s41, 0
    s_cbranch_scc1 Q_fin
    v_add_u32 v8, 16384, v8
    v_add_u32 v9, 16384, v9
    v_add_u32 v10, 16384, v10
    v_add_u32 v11, 16384, v11
    v_add_u32 v12, 16384, v12
    v_add_u32 v13, 16384, v13
    v_add_u32 v3, 12, v19
    v_mov_b32 v2, 1
    s_mov_b64 exec, 31
    global_atomic_add v3, v2, s[38:39] sc1
    s_mov_b64 exec, -1
    s_branch Q_o
Q_fin:
    v_add_u32 v19, 8, v19
    s_waitcnt vmcnt(0)
    v_mov_b32 v2, 1
    s_mov_b64 exec, 31
    global_atomic_add v19, v2, s[38:39] sc1
    s_mov_b64 exec, -1
    s_endpgm
notG:
    s_mul_i32 s52, s5, 2400
    s_add_u32 s52, s52, 6356992
    v_lshl_add_u32 v8, v1, 4, s52
    v_min_u32 v9, 21, v1
    v_lshl_add_u32 v9, v9, 4, s52
    v_mov_b32 v12, 0
    v_mov_b32 v13, 0
    v_mov_b32 v14, 0
    v_mov_b32 v15, 0
    s_waitcnt lgkmcnt(0)
    global_store_dwordx4 v8, v[12:15], s[38:39] offset:0 sc1
    global_store_dwordx4 v8, v[12:15], s[38:39] offset:1024 sc1
    global_store_dwordx4 v9, v[12:15], s[38:39] offset:2048 sc1
    s_waitcnt vmcnt(0)
    v_mov_b32 v10, 0
    v_mov_b32 v11, 1
    s_mov_b64 exec, 1
    s_barrier
    global_atomic_add v10, v11, s[36:37] sc1
    s_mov_b64 exec, -1
    s_mul_i32 s52, s5, 12800
    v_min_u32 v8, 49, v1
    v_lshl_add_u32 v8, v8, 8, s52
    global_load_dword v12, v8, s[30:31]
    global_load_dword v13, v8, s[30:31] offset:128
    s_barrier
    s_mov_b32 s66, 300000
poll5:
    global_load_dword v11, v10, s[36:37] sc1
poll5c:
    s_waitcnt vmcnt(0)
    v_cmp_le_u32 vcc, 64, v11
    s_nop 0
    s_and_b32 vcc_lo, vcc_lo, 1
    s_cmp_eq_u32 vcc_lo, 1
    s_cbranch_scc1 poll5d
    s_sleep 16
    s_sub_u32 s66, s66, 1
    s_cmp_lg_u32 s66, 0
    s_cbranch_scc1 poll5
poll5d:
    s_mov_b64 exec, 1
    v_mov_b32 v10, 6510080
    v_mov_b32 v11, 1
    global_atomic_add v13, v10, v11, s[38:39] sc0 sc1
    v_mov_b32 v10, 128
    s_waitcnt vmcnt(0)
    v_add_u32 v13, v13, v11
    v_cmp_eq_u32 vcc, 64, v13
    s_nop 0
    s_and_b64 exec, exec, vcc
    s_cbranch_execz ls6
    global_store_dword v10, v11, s[36:37] sc1
ls6:
    s_mov_b64 exec, -1
    s_branch T_done
T_tr2:
    s_min_u32 s45, s53, 9
    s_lshl_b32 s45, s45, 7
    s_add_u32 s45, s44, s45
    s_add_u32 s48, s8, s45
    s_addc_u32 s49, s9, 0
    v_mul_u32_u24 v6, 34816, v3
    v_lshl_add_u32 v6, v2, 4, v6
    s_lshl_b32 s46, s41, 7
    s_add_u32 s55, s46, 9437184
    s_mov_b32 s46, 0x05040100
    s_mov_b32 s47, 0x07060302
    v_min_u32 v9, 149, v0
    v_lshlrev_b32 v9, 7, v9
    s_mul_i32 s54, s5, 19200
    s_add_u32 s54, s54, 1228800
    v_add_u32 v9, s54, v9
    s_min_u32 s57, s43, 9
    s_lshl_b32 s57, s57, 7
    v_lshl_add_u32 v10, v3, 4, s57
    global_load_dwordx4 v[132:135], v10, s[32:33]
    s_min_u32 s57, s53, 9
    s_lshl_b32 s57, s57, 7
    v_lshl_add_u32 v10, v3, 4, s57
    global_load_dwordx4 v[136:139], v10, s[32:33]
    v_mov_b32 v140, 0
    v_mov_b32 v141, 0
    v_mov_b32 v142, 0
    v_mov_b32 v143, 0
    v_mov_b32 v144, 0
    v_mov_b32 v145, 0
    v_mov_b32 v146, 0
    v_mov_b32 v147, 0
    s_waitcnt vmcnt(0)
    s_mov_b32 s56, 5
T_loop:
    s_cmp_ge_u32 s43, s56
    s_cbranch_scc1 T_skip
    s_mul_i32 s45, s43, 278528
    s_add_u32 s45, s45, s55
    s_add_u32 s50, s38, s45
    s_addc_u32 s51, s39, 0
    v_perm_b32 v48, v20, v16, s46
    v_perm_b32 v49, v28, v24, s46
    v_perm_b32 v50, v36, v32, s46
    v_perm_b32 v51, v44, v40, s46
    global_store_dwordx4 v6, v[48:51], s[50:51] sc1
    s_add_u32 s50, s50, 4352
    s_addc_u32 s51, s51, 0
    v_perm_b32 v52, v20, v16, s47
    v_perm_b32 v53, v28, v24, s47
    v_perm_b32 v54, v36, v32, s47
    v_perm_b32 v55, v44, v40, s47
    global_store_dwordx4 v6, v[52:55], s[50:51] sc1
    s_add_u32 s50, s50, 4352
    s_addc_u32 s51, s51, 0
    v_perm_b32 v56, v21, v17, s46
    v_perm_b32 v57, v29, v25, s46
    v_perm_b32 v58, v37, v33, s46
    v_perm_b32 v59, v45, v41, s46
    global_store_dwordx4 v6, v[56:59], s[50:51] sc1
    s_add_u32 s50, s50, 4352
    s_addc_u32 s51, s51, 0
    v_perm_b32 v60, v21, v17, s47
    v_perm_b32 v61, v29, v25, s47
    v_perm_b32 v62, v37, v33, s47
    v_perm_b32 v63, v45, v41, s47
    global_store_dwordx4 v6, v[60:63], s[50:51] sc1
    s_add_u32 s50, s50, 4352
    s_addc_u32 s51, s51, 0
    v_perm_b32 v64, v22, v18, s46
    v_perm_b32 v65, v30, v26, s46
    v_perm_b32 v66, v38, v34, s46
    v_perm_b32 v67, v46, v42, s46
    global_store_dwordx4 v6, v[64:67], s[50:51] sc1
    s_add_u32 s50, s50, 4352
    s_addc_u32 s51, s51, 0
    v_perm_b32 v68, v22, v18, s47
    v_perm_b32 v69, v30, v26, s47
    v_perm_b32 v70, v38, v34, s47
    v_perm_b32 v71, v46, v42, s47
    global_store_dwordx4 v6, v[68:71], s[50:51] sc1
    s_add_u32 s50, s50, 4352
    s_addc_u32 s51, s51, 0
    v_perm_b32 v72, v23, v19, s46
    v_perm_b32 v73, v31, v27, s46
    v_perm_b32 v74, v39, v35, s46
    v_perm_b32 v75, v47, v43, s46
    global_store_dwordx4 v6, v[72:75], s[50:51] sc1
    s_add_u32 s50, s50, 4352
    s_addc_u32 s51, s51, 0
    v_perm_b32 v76, v23, v19, s47
    v_perm_b32 v77, v31, v27, s47
    v_perm_b32 v78, v39, v35, s47
    v_perm_b32 v79, v47, v43, s47
    global_store_dwordx4 v6, v[76:79], s[50:51] sc1
    s_add_u32 s50, s50, 4352
    s_addc_u32 s51, s51, 0
    v_dot2_f32_bf16 v140, v16, v132, v140
    v_dot2_f32_bf16 v141, v20, v132, v141
    v_dot2_f32_bf16 v142, v24, v132, v142
    v_dot2_f32_bf16 v143, v28, v132, v143
    v_dot2_f32_bf16 v144, v32, v132, v144
    v_dot2_f32_bf16 v145, v36, v132, v145
    v_dot2_f32_bf16 v146, v40, v132, v146
    v_dot2_f32_bf16 v147, v44, v132, v147
    v_dot2_f32_bf16 v140, v17, v133, v140
    v_dot2_f32_bf16 v141, v21, v133, v141
    v_dot2_f32_bf16 v142, v25, v133, v142
    v_dot2_f32_bf16 v143, v29, v133, v143
    v_dot2_f32_bf16 v144, v33, v133, v144
    v_dot2_f32_bf16 v145, v37, v133, v145
    v_dot2_f32_bf16 v146, v41, v133, v146
    v_dot2_f32_bf16 v147, v45, v133, v147
    v_dot2_f32_bf16 v140, v18, v134, v140
    v_dot2_f32_bf16 v141, v22, v134, v141
    v_dot2_f32_bf16 v142, v26, v134, v142
    v_dot2_f32_bf16 v143, v30, v134, v143
    v_dot2_f32_bf16 v144, v34, v134, v144
    v_dot2_f32_bf16 v145, v38, v134, v145
    v_dot2_f32_bf16 v146, v42, v134, v146
    v_dot2_f32_bf16 v147, v46, v134, v147
    v_dot2_f32_bf16 v140, v19, v135, v140
    v_dot2_f32_bf16 v141, v23, v135, v141
    v_dot2_f32_bf16 v142, v27, v135, v142
    v_dot2_f32_bf16 v143, v31, v135, v143
    v_dot2_f32_bf16 v144, v35, v135, v144
    v_dot2_f32_bf16 v145, v39, v135, v145
    v_dot2_f32_bf16 v146, v43, v135, v146
    v_dot2_f32_bf16 v147, v47, v135, v147
T_skip:
    v_mov_b32 v132, v136
    v_mov_b32 v133, v137
    v_mov_b32 v134, v138
    v_mov_b32 v135, v139
    s_cmp_eq_u32 s56, 10
    s_cbranch_scc1 T_fin
    global_load_dwordx4 v[16:19], v4, s[48:49] offset:0
    global_load_dwordx4 v[20:23], v4, s[48:49] offset:1280
    global_load_dwordx4 v[24:27], v4, s[48:49] offset:2560
    global_load_dwordx4 v[28:31], v4, s[48:49] offset:3840
    global_load_dwordx4 v[32:35], v5, s[48:49] offset:0
    global_load_dwordx4 v[36:39], v5, s[48:49] offset:1280
    global_load_dwordx4 v[40:43], v5, s[48:49] offset:2560
    global_load_dwordx4 v[44:47], v5, s[48:49] offset:3840
    global_load_dword v129, v9, s[28:29]
    s_mov_b32 s43, s53
    s_mov_b32 s56, 10
    s_waitcnt vmcnt(9)
    s_barrier
    s_waitcnt vmcnt(1)
    s_branch T_loop
T_fin:
    s_nop 3
    v_add_f32_dpp v140, v140, v140 quad_perm:[1,0,3,2] row_mask:0xf bank_mask:0xf
    v_add_f32_dpp v141, v141, v141 quad_perm:[1,0,3,2] row_mask:0xf bank_mask:0xf
    v_add_f32_dpp v142, v142, v142 quad_perm:[1,0,3,2] row_mask:0xf bank_mask:0xf
    v_add_f32_dpp v143, v143, v143 quad_perm:[1,0,3,2] row_mask:0xf bank_mask:0xf
    v_add_f32_dpp v144, v144, v144 quad_perm:[1,0,3,2] row_mask:0xf bank_mask:0xf
    v_add_f32_dpp v145, v145, v145 quad_perm:[1,0,3,2] row_mask:0xf bank_mask:0xf
    v_add_f32_dpp v146, v146, v146 quad_perm:[1,0,3,2] row_mask:0xf bank_mask:0xf
    v_add_f32_dpp v147, v147, v147 quad_perm:[1,0,3,2] row_mask:0xf bank_mask:0xf
    v_add_f32_dpp v140, v140, v140 quad_perm:[2,3,0,1] row_mask:0xf bank_mask:0xf
    v_add_f32_dpp v141, v141, v141 quad_perm:[2,3,0,1] row_mask:0xf bank_mask:0xf
    v_add_f32_dpp v142, v142, v142 quad_perm:[2,3,0,1] row_mask:0xf bank_mask:0xf
    v_add_f32_dpp v143, v143, v143 quad_perm:[2,3,0,1] row_mask:0xf bank_mask:0xf
    v_add_f32_dpp v144, v144, v144 quad_perm:[2,3,0,1] row_mask:0xf bank_mask:0xf
    v_add_f32_dpp v145, v145, v145 quad_perm:[2,3,0,1] row_mask:0xf bank_mask:0xf
    v_add_f32_dpp v146, v146, v146 quad_perm:[2,3,0,1] row_mask:0xf bank_mask:0xf
    v_add_f32_dpp v147, v147, v147 quad_perm:[2,3,0,1] row_mask:0xf bank_mask:0xf
    v_add_f32_dpp v140, v140, v140 row_half_mirror row_mask:0xf bank_mask:0xf
    v_add_f32_dpp v141, v141, v141 row_half_mirror row_mask:0xf bank_mask:0xf
    v_add_f32_dpp v142, v142, v142 row_half_mirror row_mask:0xf bank_mask:0xf
    v_add_f32_dpp v143, v143, v143 row_half_mirror row_mask:0xf bank_mask:0xf
    v_add_f32_dpp v144, v144, v144 row_half_mirror row_mask:0xf bank_mask:0xf
    v_add_f32_dpp v145, v145, v145 row_half_mirror row_mask:0xf bank_mask:0xf
    v_add_f32_dpp v146, v146, v146 row_half_mirror row_mask:0xf bank_mask:0xf
    v_add_f32_dpp v147, v147, v147 row_half_mirror row_mask:0xf bank_mask:0xf
    v_cmp_eq_u32 vcc, 1, v3
    s_nop 1
    v_cndmask_b32 v140, v140, v141, vcc
    v_cmp_eq_u32 vcc, 2, v3
    s_nop 1
    v_cndmask_b32 v140, v140, v142, vcc
    v_cmp_eq_u32 vcc, 3, v3
    s_nop 1
    v_cndmask_b32 v140, v140, v143, vcc
    v_cmp_eq_u32 vcc, 4, v3
    s_nop 1
    v_cndmask_b32 v140, v140, v144, vcc
    v_cmp_eq_u32 vcc, 5, v3
    s_nop 1
    v_cndmask_b32 v140, v140, v145, vcc
    v_cmp_eq_u32 vcc, 6, v3
    s_nop 1
    v_cndmask_b32 v140, v140, v146, vcc
    v_cmp_eq_u32 vcc, 7, v3
    s_nop 1
    v_cndmask_b32 v140, v140, v147, vcc
    s_lshl_b32 s57, s41, 11
    s_lshl_b32 s58, s42, 2
    s_add_u32 s58, s58, s40
    s_lshl_b32 s58, s58, 2
    s_add_u32 s57, s57, s58
    s_add_u32 s57, s57, 6291456
    v_lshl_add_u32 v10, v1, 5, s57
    global_store_dword v10, v140, s[38:39] sc1
    s_waitcnt vmcnt(0)
    s_barrier
T_done:
    s_barrier
    s_cmp_ge_u32 s2, 224
    s_cbranch_scc1 T_exit
    s_sub_u32 s24, s2, 64
    s_mov_b32 s25, 0
F_redo:
    s_mov_b32 s10, 0
    v_mov_b32 v63, 0
    s_and_b32 s20, s24, 7
    s_lshr_b32 s21, s24, 3
    s_mul_i32 s22, s21, 52
    s_lshr_b32 s22, s22, 8
    s_lshl_b32 s16, s20, 2
    s_add_u32 s16, s16, s22
    s_mul_i32 s22, s22, 5
    s_sub_u32 s17, s21, s22
    s_and_b32 s18, s17, 3
    s_mov_b32 s11, 0
    s_lshl_b32 s19, s40, 10
    s_mov_b32 s12, s30
    s_and_b32 s13, s31, 0xffff
    s_mov_b32 s14, 819200
    s_mov_b32 s15, 0x20000
    v_lshrrev_b32 v220, 4, v0
    v_and_b32 v221, 15, v0
    v_and_b32 v222, 3, v220
    v_lshlrev_b32 v222, 2, v222
    v_xor_b32 v221, v221, v222
    v_mul_u32_u24 v220, 1280, v220
    v_lshl_add_u32 v220, v221, 4, v220
    s_lshl_b32 s20, s17, 8
    v_add_u32 v220, s20, v220
    s_xor_b32 s20, s18, 0
    s_mul_i32 s26, s20, 204800
    s_xor_b32 s20, s18, 1
    s_mul_i32 s27, s20, 204800
    s_xor_b32 s20, s18, 2
    s_mul_i32 s28, s20, 204800
    s_xor_b32 s20, s18, 3
    s_mul_i32 s29, s20, 204800
    v_bfe_u32 v236, v1, 2, 2
    v_lshrrev_b32 v237, 5, v1
    v_and_b32 v234, 1, v1
    v_bfe_u32 v235, v1, 1, 1
    v_lshl_add_u32 v234, v234, 1, v235
    s_lshl_b32 s20, s40, 6
    v_lshl_add_u32 v234, v234, 3, s20
    v_bfe_u32 v235, v1, 4, 1
    v_lshl_add_u32 v234, v235, 5, v234
    v_lshlrev_b32 v235, 6, v236
    v_xor_b32 v234, v234, v235
    v_lshl_add_u32 v234, v236, 8, v234
    v_mul_u32_u24 v235, 5120, v237
    v_add_u32 v235, 4096, v235
    v_add_u32 v235, v235, v234
    v_lshl_add_u32 v234, v237, 10, v234
    v_add_u32 v236, 40960, v234
    v_add_u32 v237, 40960, v235
    s_add_u32 m0, s19, 0
    s_add_u32 s20, s26, 0
    buffer_load_dwordx4 v220, s[12:15], s20 offen lds
    s_add_u32 m0, s19, 4096
    s_add_u32 s20, s26, 20480
    buffer_load_dwordx4 v220, s[12:15], s20 offen lds
    s_add_u32 m0, s19, 8192
    s_add_u32 s20, s26, 40960
    buffer_load_dwordx4 v220, s[12:15], s20 offen lds
    s_add_u32 m0, s19, 12288
    s_add_u32 s20, s26, 61440
    buffer_load_dwordx4 v220, s[12:15], s20 offen lds
    s_add_u32 m0, s19, 16384
    s_add_u32 s20, s26, 81920
    buffer_load_dwordx4 v220, s[12:15], s20 offen lds
    s_add_u32 m0, s19, 20480
    s_add_u32 s20, s26, 102400
    buffer_load_dwordx4 v220, s[12:15], s20 offen lds
    s_add_u32 m0, s19, 24576
    s_add_u32 s20, s26, 122880
    buffer_load_dwordx4 v220, s[12:15], s20 offen lds
    s_add_u32 m0, s19, 28672
    s_add_u32 s20, s26, 143360
    buffer_load_dwordx4 v220, s[12:15], s20 offen lds
    s_add_u32 m0, s19, 32768
    s_add_u32 s20, s26, 163840
    buffer_load_dwordx4 v220, s[12:15], s20 offen lds
    s_add_u32 m0, s19, 36864
    s_add_u32 s20, s26, 184320
    buffer_load_dwordx4 v220, s[12:15], s20 offen lds
    s_add_u32 m0, s19, 40960
    s_add_u32 s20, s27, 0
    buffer_load_dwordx4 v220, s[12:15], s20 offen lds
    s_add_u32 m0, s19, 45056
    s_add_u32 s20, s27, 20480
    buffer_load_dwordx4 v220, s[12:15], s20 offen lds
    s_add_u32 m0, s19, 49152
    s_add_u32 s20, s27, 40960
    buffer_load_dwordx4 v220, s[12:15], s20 offen lds
    s_add_u32 m0, s19, 53248
    s_add_u32 s20, s27, 61440
    buffer_load_dwordx4 v220, s[12:15], s20 offen lds
    s_add_u32 m0, s19, 57344
    s_add_u32 s20, s27, 81920
    buffer_load_dwordx4 v220, s[12:15], s20 offen lds
    s_add_u32 m0, s19, 61440
    s_add_u32 s20, s27, 102400
    buffer_load_dwordx4 v220, s[12:15], s20 offen lds
    s_add_u32 m0, s19, 65536
    s_add_u32 s20, s27, 122880
    buffer_load_dwordx4 v220, s[12:15], s20 offen lds
    s_add_u32 m0, s19, 69632
    s_add_u32 s20, s27, 143360
    buffer_load_dwordx4 v220, s[12:15], s20 offen lds
    s_add_u32 m0, s19, 73728
    s_add_u32 s20, s27, 163840
    buffer_load_dwordx4 v220, s[12:15], s20 offen lds
    s_add_u32 m0, s19, 77824
    s_add_u32 s20, s27, 184320
    buffer_load_dwordx4 v220, s[12:15], s20 offen lds
    s_waitcnt vmcnt(5)
    s_barrier
    ds_read_b64_tr_b16 v[96:97], v234 offset:0
    ds_read_b64_tr_b16 v[98:99], v234 offset:5120
    ds_read_b64_tr_b16 v[100:101], v234 offset:2048
    ds_read_b64_tr_b16 v[102:103], v234 offset:7168
    ds_read_b64_tr_b16 v[104:105], v234 offset:10240
    ds_read_b64_tr_b16 v[106:107], v234 offset:15360
    ds_read_b64_tr_b16 v[108:109], v234 offset:12288
    ds_read_b64_tr_b16 v[110:111], v234 offset:17408
    ds_read_b64_tr_b16 v[128:129], v235 offset:0
    ds_read_b64_tr_b16 v[132:133], v235 offset:10240
    ds_read_b64_tr_b16 v[112:113], v234 offset:20480
    ds_read_b64_tr_b16 v[114:115], v234 offset:25600
    ds_read_b64_tr_b16 v[116:117], v234 offset:22528
    ds_read_b64_tr_b16 v[118:119], v234 offset:27648
    ds_read_b64_tr_b16 v[120:121], v234 offset:30720
    ds_read_b64_tr_b16 v[122:123], v234 offset:35840
    ds_read_b64_tr_b16 v[124:125], v234 offset:32768
    ds_read_b64_tr_b16 v[126:127], v234 offset:37888
    ds_read_b64_tr_b16 v[130:131], v235 offset:20480
    ds_read_b64_tr_b16 v[134:135], v235 offset:30720
    ds_read_b64_tr_b16 v[136:137], v236 offset:0
    ds_read_b64_tr_b16 v[138:139], v236 offset:5120
    ds_read_b64_tr_b16 v[140:141], v236 offset:2048
    ds_read_b64_tr_b16 v[142:143], v236 offset:7168
    ds_read_b64_tr_b16 v[144:145], v236 offset:10240
    ds_read_b64_tr_b16 v[146:147], v236 offset:15360
    ds_read_b64_tr_b16 v[148:149], v236 offset:12288
    ds_read_b64_tr_b16 v[150:151], v236 offset:17408
    ds_read_b64_tr_b16 v[168:169], v237 offset:0
    ds_read_b64_tr_b16 v[172:173], v237 offset:10240
    s_waitcnt lgkmcnt(0)
    s_barrier
F_entry:
    v_mov_b32 v44, 128
    global_load_dword v45, v44, s[36:37] sc1
    s_add_u32 m0, s19, 0
    s_add_u32 s20, s28, 0
    buffer_load_dwordx4 v220, s[12:15], s20 offen lds
    s_add_u32 m0, s19, 4096
    s_add_u32 s20, s28, 20480
    buffer_load_dwordx4 v220, s[12:15], s20 offen lds
    s_add_u32 m0, s19, 8192
    s_add_u32 s20, s28, 40960
    buffer_load_dwordx4 v220, s[12:15], s20 offen lds
    s_add_u32 m0, s19, 12288
    s_add_u32 s20, s28, 61440
    buffer_load_dwordx4 v220, s[12:15], s20 offen lds
    s_add_u32 m0, s19, 16384
    s_add_u32 s20, s28, 81920
    buffer_load_dwordx4 v220, s[12:15], s20 offen lds
    s_add_u32 m0, s19, 20480
    s_add_u32 s20, s28, 102400
    buffer_load_dwordx4 v220, s[12:15], s20 offen lds
    s_add_u32 m0, s19, 24576
    s_add_u32 s20, s28, 122880
    buffer_load_dwordx4 v220, s[12:15], s20 offen lds
    s_add_u32 m0, s19, 28672
    s_add_u32 s20, s28, 143360
    buffer_load_dwordx4 v220, s[12:15], s20 offen lds
    s_add_u32 m0, s19, 32768
    s_add_u32 s20, s28, 163840
    buffer_load_dwordx4 v220, s[12:15], s20 offen lds
    s_add_u32 m0, s19, 36864
    s_add_u32 s20, s28, 184320
    buffer_load_dwordx4 v220, s[12:15], s20 offen lds
    v_mov_b32 v2, v234
    v_mov_b32 v3, v235
    v_mov_b32 v6, v236
    v_mov_b32 v7, v237
    s_mov_b32 s56, s18
    s_lshl_b32 s45, s40, 10
    v_bfe_u32 v10, v1, 2, 2
    v_and_b32 v11, 3, v1
    v_bfe_u32 v8, v1, 4, 1
    v_lshrrev_b32 v9, 5, v1
    s_add_u32 m0, s19, 40960
    s_add_u32 s20, s29, 0
    buffer_load_dwordx4 v220, s[12:15], s20 offen lds
    s_add_u32 m0, s19, 45056
    s_add_u32 s20, s29, 20480
    buffer_load_dwordx4 v220, s[12:15], s20 offen lds
    s_add_u32 m0, s19, 49152
    s_add_u32 s20, s29, 40960
    buffer_load_dwordx4 v220, s[12:15], s20 offen lds
    s_add_u32 m0, s19, 53248
    s_add_u32 s20, s29, 61440
    buffer_load_dwordx4 v220, s[12:15], s20 offen lds
    s_add_u32 m0, s19, 57344
    s_add_u32 s20, s29, 81920
    buffer_load_dwordx4 v220, s[12:15], s20 offen lds
    s_mov_b32 s52, s38
    s_and_b32 s53, s39, 0xffff
    s_mov_b32 s54, 12582912
    s_mov_b32 s55, 0x20000
    v_lshlrev_b32 v46, 4, v1
    s_mul_i32 s41, s16, 5
    s_add_u32 s41, s41, s17
    s_lshl_b32 s41, s41, 8
    s_add_u32 s41, s41, 6427648
    s_lshl_b32 s42, s17, 2
    s_add_u32 s42, s42, s40
    s_lshl_b32 s42, s42, 11
    s_add_u32 s42, s42, 6468608
    v_min_u32 v20, 15, v1
    v_lshl_add_u32 v20, v20, 7, s42
    s_add_u32 s41, s41, s25
    v_mov_b32 v21, s41
    v_lshrrev_b32 v22, 3, v1
    v_and_b32 v23, 7, v1
    v_mul_u32_u24 v22, 4352, v22
    v_lshl_add_u32 v22, v23, 4, v22
    s_lshl_b32 s57, s17, 2
    s_add_u32 s57, s57, s40
    s_mul_i32 s57, s57, 139264
    s_lshl_b32 s42, s16, 7
    s_add_u32 s57, s57, s42
    s_lshl_b32 s58, s40, 12
    v_lshl_add_u32 v23, v9, 3, v10
    v_lshlrev_b32 v23, 7, v23
    v_lshl_add_u32 v23, v8, 5, v23
    v_lshl_add_u32 v23, v11, 3, v23
    s_lshl_b32 s42, s11, 6
    s_add_u32 s42, s42, s58
    v_add_u32 v23, s42, v23
    v_and_b32 v24, 31, v1
    s_lshl_b32 s41, s16, 6
    v_add_u32 v24, s41, v24
    s_lshl_b32 s42, s11, 7
    s_add_u32 s42, s42, 6291456
    v_lshl_add_u32 v25, v24, 5, s42
    v_mul_u32_u24 v24, 1280, v24
    v_lshl_add_u32 v24, v9, 4, v24
    s_lshl_b32 s41, s17, 8
    s_lshl_b32 s42, s40, 6
    s_add_u32 s41, s41, s42
    v_and_b32 v24, 31, v1
    v_mul_u32_u24 v24, 272, v24
    v_lshl_add_u32 v24, v9, 4, v24
    s_add_u32 s42, s42, 20480
    v_add_u32 v47, s42, v24
    v_lshrrev_b32 v24, 4, v1
    s_lshl_b32 s42, s40, 3
    v_add_u32 v24, s42, v24
    v_and_b32 v26, 15, v1
    v_mul_u32_u24 v27, 272, v24
    v_lshl_add_u32 v27, v26, 4, v27
    v_add_u32 v27, 20480, v27
    s_lshl_b32 s42, s16, 6
    v_add_u32 v24, s42, v24
    v_mul_u32_u24 v24, 1280, v24
    v_lshl_add_u32 v24, v26, 4, v24
    s_lshl_b32 s41, s17, 8
    v_add_u32 v5, s41, v24
    v_and_b32 v24, 15, v1
    v_lshl_add_u32 v24, v9, 4, v24
    v_lshlrev_b32 v24, 4, v24
    v_lshl_add_u32 v4, v8, 12, v24
    v_lshl_add_u32 v24, v8, 3, v24
    v_mov_b32 v26, v24
    s_lshl_b32 s47, s16, 1
    s_add_u32 s47, s47, s11
    s_mul_i32 s47, s47, 40960
    s_add_u32 s47, s47, 3145728
    s_mul_i32 s43, s11, 81920
    s_sub_u32 s43, 40960, s43
    s_xor_b32 s41, s56, 0
    s_mul_i32 s41, s41, 10240
    s_add_u32 s41, s41, s47
    s_add_u32 s60, s41, s45
    s_xor_b32 s41, s56, 1
    s_mul_i32 s41, s41, 10240
    s_add_u32 s41, s41, s47
    s_add_u32 s61, s41, s45
    s_sub_u32 s61, s61, 10240
    s_xor_b32 s41, s56, 2
    s_mul_i32 s41, s41, 10240
    s_add_u32 s41, s41, s47
    s_add_u32 s62, s41, s45
    s_xor_b32 s41, s56, 3
    s_mul_i32 s41, s41, 10240
    s_add_u32 s41, s41, s47
    s_add_u32 s63, s41, s45
    s_sub_u32 s63, s63, 10240
    s_cmp_lt_u32 s40, 2
    s_cselect_b32 s64, s60, s61
    s_cselect_b32 s65, s62, s63
    s_waitcnt vmcnt(15)
    s_barrier
    ds_read_b64_tr_b16 v[152:153], v6 offset:20480
    ds_read_b64_tr_b16 v[154:155], v6 offset:25600
    ds_read_b64_tr_b16 v[156:157], v6 offset:22528
    ds_read_b64_tr_b16 v[158:159], v6 offset:27648
    ds_read_b64_tr_b16 v[160:161], v6 offset:30720
    ds_read_b64_tr_b16 v[162:163], v6 offset:35840
    ds_read_b64_tr_b16 v[164:165], v6 offset:32768
    ds_read_b64_tr_b16 v[166:167], v6 offset:37888
    ds_read_b64_tr_b16 v[170:171], v7 offset:20480
    ds_read_b64_tr_b16 v[174:175], v7 offset:30720
    s_waitcnt vmcnt(10) lgkmcnt(0)
    s_barrier
    s_add_u32 m0, s19, 61440
    s_add_u32 s20, s29, 102400
    buffer_load_dwordx4 v220, s[12:15], s20 offen lds
    s_add_u32 m0, s19, 65536
    s_add_u32 s20, s29, 122880
    buffer_load_dwordx4 v220, s[12:15], s20 offen lds
    s_add_u32 m0, s19, 69632
    s_add_u32 s20, s29, 143360
    buffer_load_dwordx4 v220, s[12:15], s20 offen lds
    s_add_u32 m0, s19, 73728
    s_add_u32 s20, s29, 163840
    buffer_load_dwordx4 v220, s[12:15], s20 offen lds
    s_add_u32 m0, s19, 77824
    s_add_u32 s20, s29, 184320
    buffer_load_dwordx4 v220, s[12:15], s20 offen lds
    s_cmp_eq_u32 s10, 0
    s_cbranch_scc1 F_nofin
    v_mov_b32 v62, 1
    s_mov_b64 exec, 65535
    global_atomic_add v63, v62, s[38:39] sc1
    s_mov_b64 exec, -1
F_nofin:
    ds_read_b64_tr_b16 v[176:177], v2 offset:0
    ds_read_b64_tr_b16 v[178:179], v2 offset:5120
    ds_read_b64_tr_b16 v[180:181], v2 offset:2048
    ds_read_b64_tr_b16 v[182:183], v2 offset:7168
    ds_read_b64_tr_b16 v[184:185], v2 offset:10240
    ds_read_b64_tr_b16 v[186:187], v2 offset:15360
    ds_read_b64_tr_b16 v[188:189], v2 offset:12288
    ds_read_b64_tr_b16 v[190:191], v2 offset:17408
    ds_read_b64_tr_b16 v[208:209], v3 offset:0
    ds_read_b64_tr_b16 v[212:213], v3 offset:10240
    s_waitcnt vmcnt(5)
    s_barrier
    ds_read_b64_tr_b16 v[192:193], v2 offset:20480
    ds_read_b64_tr_b16 v[194:195], v2 offset:25600
    ds_read_b64_tr_b16 v[196:197], v2 offset:22528
    ds_read_b64_tr_b16 v[198:199], v2 offset:27648
    ds_read_b64_tr_b16 v[200:201], v2 offset:30720
    ds_read_b64_tr_b16 v[202:203], v2 offset:35840
    ds_read_b64_tr_b16 v[204:205], v2 offset:32768
    ds_read_b64_tr_b16 v[206:207], v2 offset:37888
    ds_read_b64_tr_b16 v[210:211], v3 offset:20480
    ds_read_b64_tr_b16 v[214:215], v3 offset:30720
    ds_read_b64_tr_b16 v[216:217], v6 offset:0
    ds_read_b64_tr_b16 v[218:219], v6 offset:5120
    ds_read_b64_tr_b16 v[220:221], v6 offset:2048
    ds_read_b64_tr_b16 v[222:223], v6 offset:7168
    ds_read_b64_tr_b16 v[224:225], v6 offset:10240
    ds_read_b64_tr_b16 v[226:227], v6 offset:15360
    ds_read_b64_tr_b16 v[228:229], v6 offset:12288
    ds_read_b64_tr_b16 v[230:231], v6 offset:17408
    ds_read_b64_tr_b16 v[248:249], v7 offset:0
    ds_read_b64_tr_b16 v[252:253], v7 offset:10240
    s_cmp_eq_u32 s10, 0
    s_cbranch_scc1 F_w0
    s_waitcnt vmcnt(1)
    s_branch F_w1
F_w0:
    s_waitcnt vmcnt(0)
F_w1:
    s_barrier
    v_readfirstlane_b32 s42, v45
    s_nop 0
    s_cmp_ge_u32 s42, 1
    s_cbranch_scc1 F_gok
    s_mov_b32 s66, 300000
poll7:
    global_load_dword v45, v44, s[36:37] sc1
poll7c:
    s_waitcnt vmcnt(0)
    v_cmp_le_u32 vcc, 1, v45
    s_nop 0
    s_and_b32 vcc_lo, vcc_lo, 1
    s_cmp_eq_u32 vcc_lo, 1
    s_cbranch_scc1 poll7d
    s_sleep 8
    s_sub_u32 s66, s66, 1
    s_cmp_lg_u32 s66, 0
    s_cbranch_scc1 poll7
poll7d:
F_gok:
    global_load_dwordx3 v[64:66], v25, s[38:39] offset:0 sc1
    global_load_dwordx3 v[68:70], v25, s[38:39] offset:16 sc1
    global_load_dwordx3 v[72:74], v25, s[38:39] offset:1024 sc1
    global_load_dwordx3 v[76:78], v25, s[38:39] offset:1040 sc1
    ds_read_b64_tr_b16 v[232:233], v6 offset:20480
    ds_read_b64_tr_b16 v[234:235], v6 offset:25600
    ds_read_b64_tr_b16 v[236:237], v6 offset:22528
    ds_read_b64_tr_b16 v[238:239], v6 offset:27648
    ds_read_b64_tr_b16 v[240:241], v6 offset:30720
    ds_read_b64_tr_b16 v[242:243], v6 offset:35840
    ds_read_b64_tr_b16 v[244:245], v6 offset:32768
    ds_read_b64_tr_b16 v[246:247], v6 offset:37888
    ds_read_b64_tr_b16 v[250:251], v7 offset:20480
    ds_read_b64_tr_b16 v[254:255], v7 offset:30720
    s_waitcnt lgkmcnt(0)
    s_mul_i32 s41, s11, 40960
    s_sub_u32 s42, 40960, s41
    v_add_u32 v2, s42, v5
    v_add_u32 v5, s41, v5
    v_add_u32 v7, 5120, v5
    v_add_u32 v3, 5120, v2
    s_cmp_lg_u32 s40, 0
    s_cbranch_scc1 F_go
    s_mov_b64 exec, 1
    s_mov_b32 s66, 300000
poll8:
    global_load_dword v6, v21, s[38:39] sc1
poll8c:
    s_waitcnt vmcnt(0)
    v_cmp_le_u32 vcc, 8, v6
    s_nop 0
    s_and_b32 vcc_lo, vcc_lo, 1
    s_cmp_eq_u32 vcc_lo, 1
    s_cbranch_scc1 poll8d
    s_sleep 1
    s_sub_u32 s66, s66, 1
    s_cmp_lg_u32 s66, 0
    s_cbranch_scc1 poll8
poll8d:
    s_mov_b64 exec, -1
F_go:
    s_barrier
    s_add_u32 m0, s45, 0
    s_add_u32 s42, s60, 0
    buffer_load_dwordx4 v46, s[52:55], s42 offen sc1 lds
    s_add_u32 m0, s45, 4096
    s_add_u32 s42, s60, 4096
    buffer_load_dwordx4 v46, s[52:55], s42 offen sc1 lds
    s_add_u32 m0, s45, 8192
    s_add_u32 s42, s64, 8192
    buffer_load_dwordx4 v46, s[52:55], s42 offen sc1 lds
    s_add_u32 m0, s45, 12288
    s_add_u32 s42, s61, 12288
    buffer_load_dwordx4 v46, s[52:55], s42 offen sc1 lds
    s_add_u32 m0, s45, 16384
    s_add_u32 s42, s61, 16384
    buffer_load_dwordx4 v46, s[52:55], s42 offen sc1 lds
    s_add_u32 m0, s45, 20480
    s_add_u32 s42, s62, 0
    buffer_load_dwordx4 v46, s[52:55], s42 offen sc1 lds
    s_add_u32 m0, s45, 24576
    s_add_u32 s42, s62, 4096
    buffer_load_dwordx4 v46, s[52:55], s42 offen sc1 lds
    s_waitcnt vmcnt(7)
    v_add_f32 v64, v64, v65
    v_add_f32 v66, v66, v68
    v_add_f32 v69, v69, v70
    v_add_f32 v64, v64, v66
    v_add_f32 v64, v64, v69
    v_mul_f32 v64, 0xbfb8aa3b, v64
    v_exp_f32 v64, v64
    s_nop 0
    v_add_f32 v64, 1.0, v64
    v_rcp_f32 v44, v64
    v_add_f32 v72, v72, v73
    v_add_f32 v74, v74, v76
    v_add_f32 v77, v77, v78
    v_add_f32 v72, v72, v74
    v_add_f32 v72, v72, v77
    v_mul_f32 v72, 0xbfb8aa3b, v72
    v_exp_f32 v72, v72
    s_nop 0
    v_add_f32 v72, 1.0, v72
    v_rcp_f32 v45, v72
    s_waitcnt vmcnt(4)
    s_barrier
    ds_read_b128 v[28:31], v4 offset:0
    ds_read_b128 v[32:35], v4 offset:512
    ds_read_b128 v[36:39], v4 offset:1024
    ds_read_b128 v[40:43], v4 offset:1536
    ds_read_b128 v[8:11], v4 offset:2048
    ds_read_b128 v[12:15], v4 offset:2560
    s_waitcnt lgkmcnt(5)
    v_mfma_f32_32x32x16_bf16 v[64:79], v[96:99], v[28:31], 0
    s_add_u32 m0, s45, 28672
    s_add_u32 s42, s65, 8192
    buffer_load_dwordx4 v46, s[52:55], s42 offen sc1 lds
    ds_read_b128 v[16:19], v4 offset:3072
    s_waitcnt lgkmcnt(5)
    v_mfma_f32_32x32x16_bf16 v[64:79], v[100:103], v[32:35], v[64:79]
    s_add_u32 m0, s45, 32768
    s_add_u32 s42, s63, 12288
    buffer_load_dwordx4 v46, s[52:55], s42 offen sc1 lds
    ds_read_b128 v[28:31], v4 offset:3584
    s_waitcnt lgkmcnt(5)
    v_mfma_f32_32x32x16_bf16 v[64:79], v[104:107], v[36:39], v[64:79]
    s_add_u32 m0, s45, 36864
    s_add_u32 s42, s63, 16384
    buffer_load_dwordx4 v46, s[52:55], s42 offen sc1 lds
    ds_read_b64 v[32:33], v24 offset:8192
    ds_read_b64 v[34:35], v24 offset:9216
    s_waitcnt lgkmcnt(6)
    v_mfma_f32_32x32x16_bf16 v[64:79], v[108:111], v[40:43], v[64:79]
    global_load_dword v6, v20, s[38:39] sc1
    ds_read_b64 v[36:37], v24 offset:8704
    ds_read_b64 v[38:39], v24 offset:9728
    s_waitcnt lgkmcnt(7)
    v_mfma_f32_32x32x16_bf16 v[64:79], v[112:115], v[8:11], v[64:79]
    s_waitcnt vmcnt(6)
    s_barrier
    ds_read_b128 v[40:43], v4 offset:10240
    s_waitcnt lgkmcnt(7)
    v_mfma_f32_32x32x16_bf16 v[64:79], v[116:119], v[12:15], v[64:79]
    ds_read_b128 v[8:11], v4 offset:10752
    s_waitcnt lgkmcnt(7)
    v_mfma_f32_32x32x16_bf16 v[64:79], v[120:123], v[16:19], v[64:79]
    ds_read_b128 v[12:15], v4 offset:11264
    s_waitcnt lgkmcnt(7)
    v_mfma_f32_32x32x16_bf16 v[64:79], v[124:127], v[28:31], v[64:79]
    ds_read_b128 v[16:19], v4 offset:11776
    s_waitcnt lgkmcnt(6)
    v_mfma_f32_32x32x16_bf16 v[64:79], v[128:131], v[32:35], v[64:79]
    ds_read_b128 v[28:31], v4 offset:12288
    s_waitcnt lgkmcnt(5)
    v_mfma_f32_32x32x16_bf16 v[64:79], v[132:135], v[36:39], v[64:79]
    ds_read_b128 v[32:35], v4 offset:12800
    s_waitcnt lgkmcnt(5)
    v_mfma_f32_32x32x16_bf16 v[64:79], v[136:139], v[40:43], v[64:79]
    s_add_u32 s60, s60, s43
    s_add_u32 m0, s45, 40960
    s_add_u32 s42, s60, 0
    buffer_load_dwordx4 v46, s[52:55], s42 offen sc1 lds
    ds_read_b128 v[36:39], v4 offset:13312
    s_waitcnt lgkmcnt(5)
    v_mfma_f32_32x32x16_bf16 v[64:79], v[140:143], v[8:11], v[64:79]
    s_add_u32 m0, s45, 45056
    s_add_u32 s42, s60, 4096
    buffer_load_dwordx4 v46, s[52:55], s42 offen sc1 lds
    ds_read_b128 v[40:43], v4 offset:13824
    s_waitcnt lgkmcnt(5)
    v_mfma_f32_32x32x16_bf16 v[64:79], v[144:147], v[12:15], v[64:79]
    s_add_u32 s64, s64, s43
    s_add_u32 m0, s45, 49152
    s_add_u32 s42, s64, 8192
    buffer_load_dwordx4 v46, s[52:55], s42 offen sc1 lds
    ds_read_b64 v[8:9], v26 offset:18432
    ds_read_b64 v[10:11], v26 offset:19456
    s_waitcnt lgkmcnt(6)
    v_mfma_f32_32x32x16_bf16 v[64:79], v[148:151], v[16:19], v[64:79]
    s_add_u32 s61, s61, s43
    s_add_u32 m0, s45, 53248
    s_add_u32 s42, s61, 12288
    buffer_load_dwordx4 v46, s[52:55], s42 offen sc1 lds
    ds_read_b64 v[12:13], v26 offset:18944
    ds_read_b64 v[14:15], v26 offset:19968
    s_waitcnt lgkmcnt(7)
    v_mfma_f32_32x32x16_bf16 v[64:79], v[152:155], v[28:31], v[64:79]
    s_add_u32 m0, s45, 57344
    s_add_u32 s42, s61, 16384
    buffer_load_dwordx4 v46, s[52:55], s42 offen sc1 lds
    s_waitcnt vmcnt(8)
    s_barrier
    ds_read_b128 v[16:19], v4 offset:20480
    s_waitcnt lgkmcnt(7)
    v_mfma_f32_32x32x16_bf16 v[64:79], v[156:159], v[32:35], v[64:79]
    ds_read_b128 v[28:31], v4 offset:20992
    s_waitcnt lgkmcnt(7)
    v_mfma_f32_32x32x16_bf16 v[64:79], v[160:163], v[36:39], v[64:79]
    s_add_u32 s62, s62, s43
    s_add_u32 m0, s45, 61440
    s_add_u32 s42, s62, 0
    buffer_load_dwordx4 v46, s[52:55], s42 offen sc1 lds
    ds_read_b128 v[32:35], v4 offset:21504
    s_waitcnt lgkmcnt(7)
    v_mfma_f32_32x32x16_bf16 v[64:79], v[164:167], v[40:43], v[64:79]
    ds_read_b128 v[36:39], v4 offset:22016
    s_waitcnt lgkmcnt(6)
    v_mfma_f32_32x32x16_bf16 v[64:79], v[168:171], v[8:11], v[64:79]
    s_add_u32 m0, s45, 65536
    s_add_u32 s42, s62, 4096
    buffer_load_dwordx4 v46, s[52:55], s42 offen sc1 lds
    ds_read_b128 v[40:43], v4 offset:22528
    s_waitcnt lgkmcnt(5)
    v_mfma_f32_32x32x16_bf16 v[64:79], v[172:175], v[12:15], v[64:79]
    ds_read_b128 v[8:11], v4 offset:23040
    s_waitcnt lgkmcnt(5)
    v_mfma_f32_32x32x16_bf16 v[64:79], v[176:179], v[16:19], v[64:79]
    s_add_u32 s65, s65, s43
    s_add_u32 m0, s45, 69632
    s_add_u32 s42, s65, 8192
    buffer_load_dwordx4 v46, s[52:55], s42 offen sc1 lds
    ds_read_b128 v[12:15], v4 offset:23552
    s_waitcnt lgkmcnt(5)
    v_mfma_f32_32x32x16_bf16 v[64:79], v[180:183], v[28:31], v[64:79]
    ds_read_b128 v[16:19], v4 offset:24064
    s_waitcnt lgkmcnt(5)
    v_mfma_f32_32x32x16_bf16 v[64:79], v[184:187], v[32:35], v[64:79]
    s_add_u32 s63, s63, s43
    s_add_u32 m0, s45, 73728
    s_add_u32 s42, s63, 12288
    buffer_load_dwordx4 v46, s[52:55], s42 offen sc1 lds
    ds_read_b64 v[28:29], v24 offset:28672
    ds_read_b64 v[30:31], v24 offset:29696
    s_waitcnt lgkmcnt(6)
    v_mfma_f32_32x32x16_bf16 v[64:79], v[188:191], v[36:39], v[64:79]
    ds_read_b64 v[32:33], v24 offset:29184
    ds_read_b64 v[34:35], v24 offset:30208
    s_waitcnt lgkmcnt(7)
    v_mfma_f32_32x32x16_bf16 v[64:79], v[192:195], v[40:43], v[64:79]
    s_add_u32 m0, s45, 77824
    s_add_u32 s42, s63, 16384
    buffer_load_dwordx4 v46, s[52:55], s42 offen sc1 lds
    s_waitcnt vmcnt(10)
    s_barrier
    v_cmp_le_u32 vcc, 1, v6
    s_nop 0
    s_cmp_eq_u32 vcc_lo, -1
    s_cbranch_scc0 F_slow
F_at:
    ds_read_b128 v[36:39], v4 offset:30720
    s_waitcnt lgkmcnt(7)
    v_mfma_f32_32x32x16_bf16 v[64:79], v[196:199], v[8:11], v[64:79]
    s_add_u32 m0, s58, 0
    s_add_u32 s42, s57, 0
    buffer_load_dwordx4 v22, s[52:55], s42 offen sc1 lds
    ds_read_b128 v[40:43], v4 offset:31232
    s_waitcnt lgkmcnt(7)
    v_mfma_f32_32x32x16_bf16 v[64:79], v[200:203], v[12:15], v[64:79]
    s_add_u32 m0, s58, 1024
    s_add_u32 s42, s57, 34816
    buffer_load_dwordx4 v22, s[52:55], s42 offen sc1 lds
    ds_read_b128 v[8:11], v4 offset:31744
    s_waitcnt lgkmcnt(7)
    v_mfma_f32_32x32x16_bf16 v[64:79], v[204:207], v[16:19], v[64:79]
    s_add_u32 m0, s58, 2048
    s_add_u32 s42, s57, 69632
    buffer_load_dwordx4 v22, s[52:55], s42 offen sc1 lds
    ds_read_b128 v[12:15], v4 offset:32256
    s_waitcnt lgkmcnt(6)
    v_mfma_f32_32x32x16_bf16 v[64:79], v[208:211], v[28:31], v[64:79]
    s_add_u32 m0, s58, 3072
    s_add_u32 s42, s57, 104448
    buffer_load_dwordx4 v22, s[52:55], s42 offen sc1 lds
    ds_read_b128 v[16:19], v4 offset:32768
    s_waitcnt lgkmcnt(5)
    v_mfma_f32_32x32x16_bf16 v[64:79], v[212:215], v[32:35], v[64:79]
    ds_read_b128 v[28:31], v4 offset:33280
    s_waitcnt lgkmcnt(5)
    v_mfma_f32_32x32x16_bf16 v[64:79], v[216:219], v[36:39], v[64:79]
    ds_read_b128 v[32:35], v4 offset:33792
    s_waitcnt lgkmcnt(5)
    v_mfma_f32_32x32x16_bf16 v[64:79], v[220:223], v[40:43], v[64:79]
    ds_read_b128 v[36:39], v4 offset:34304
    s_waitcnt lgkmcnt(5)
    v_mfma_f32_32x32x16_bf16 v[64:79], v[224:227], v[8:11], v[64:79]
    ds_read_b64 v[40:41], v26 offset:38912
    ds_read_b64 v[42:43], v26 offset:39936
    s_waitcnt lgkmcnt(6)
    v_mfma_f32_32x32x16_bf16 v[64:79], v[228:231], v[12:15], v[64:79]
    ds_read_b64 v[8:9], v26 offset:39424
    ds_read_b64 v[10:11], v26 offset:40448
    s_waitcnt lgkmcnt(7)
    v_mfma_f32_32x32x16_bf16 v[64:79], v[232:235], v[16:19], v[64:79]
    s_waitcnt vmcnt(11)
    s_barrier
    v_add_u32 v4, 40960, v4
    v_add_u32 v24, 40960, v24
    v_add_u32 v26, 40960, v26
    ds_read_b128 v[12:15], v4 offset:0
    s_waitcnt lgkmcnt(7)
    v_mfma_f32_32x32x16_bf16 v[64:79], v[236:239], v[28:31], v[64:79]
    ds_read_b128 v[16:19], v4 offset:512
    s_waitcnt lgkmcnt(7)
    v_mfma_f32_32x32x16_bf16 v[64:79], v[240:243], v[32:35], v[64:79]
    ds_read_b128 v[28:31], v4 offset:1024
    s_waitcnt lgkmcnt(7)
    v_mfma_f32_32x32x16_bf16 v[64:79], v[244:247], v[36:39], v[64:79]
    ds_read_b128 v[32:35], v4 offset:1536
    s_waitcnt lgkmcnt(6)
    v_mfma_f32_32x32x16_bf16 v[64:79], v[248:251], v[40:43], v[64:79]
    ds_read_b128 v[36:39], v4 offset:2048
    s_waitcnt lgkmcnt(5)
    v_mfma_f32_32x32x16_bf16 v[64:79], v[252:255], v[8:11], v[64:79]
    ds_read_b128 v[40:43], v4 offset:2560
    s_waitcnt lgkmcnt(5)
    v_mfma_f32_32x32x16_bf16 v[80:95], v[96:99], v[12:15], 0
    ds_read_b128 v[8:11], v4 offset:3072
    s_waitcnt lgkmcnt(5)
    v_mfma_f32_32x32x16_bf16 v[80:95], v[100:103], v[16:19], v[80:95]
    ds_read_b128 v[12:15], v4 offset:3584
    s_waitcnt lgkmcnt(5)
    v_mfma_f32_32x32x16_bf16 v[80:95], v[104:107], v[28:31], v[80:95]
    ds_read_b64 v[16:17], v24 offset:8192
    ds_read_b64 v[18:19], v24 offset:9216
    s_waitcnt lgkmcnt(6)
    v_mfma_f32_32x32x16_bf16 v[80:95], v[108:111], v[32:35], v[80:95]
    ds_read_b64 v[28:29], v24 offset:8704
    ds_read_b64 v[30:31], v24 offset:9728
    s_waitcnt lgkmcnt(7)
    v_mfma_f32_32x32x16_bf16 v[80:95], v[112:115], v[36:39], v[80:95]
    s_waitcnt vmcnt(9)
    s_barrier
    ds_read_b128 v[32:35], v4 offset:10240
    s_waitcnt lgkmcnt(7)
    v_mfma_f32_32x32x16_bf16 v[80:95], v[116:119], v[40:43], v[80:95]
    ds_read_b128 v[36:39], v4 offset:10752
    s_waitcnt lgkmcnt(7)
    v_mfma_f32_32x32x16_bf16 v[80:95], v[120:123], v[8:11], v[80:95]
    ds_read_b128 v[40:43], v4 offset:11264
    s_waitcnt lgkmcnt(7)
    v_mfma_f32_32x32x16_bf16 v[80:95], v[124:127], v[12:15], v[80:95]
    ds_read_b128 v[8:11], v4 offset:11776
    s_waitcnt lgkmcnt(6)
    v_mfma_f32_32x32x16_bf16 v[80:95], v[128:131], v[16:19], v[80:95]
    ds_read_b128 v[12:15], v4 offset:12288
    s_waitcnt lgkmcnt(5)
    v_mfma_f32_32x32x16_bf16 v[80:95], v[132:135], v[28:31], v[80:95]
    ds_read_b128 v[16:19], v4 offset:12800
    s_waitcnt lgkmcnt(5)
    v_mfma_f32_32x32x16_bf16 v[80:95], v[136:139], v[32:35], v[80:95]
    ds_read_b128 v[28:31], v4 offset:13312
    s_waitcnt lgkmcnt(5)
    v_mfma_f32_32x32x16_bf16 v[80:95], v[140:143], v[36:39], v[80:95]
    ds_read_b128 v[32:35], v4 offset:13824
    s_waitcnt lgkmcnt(5)
    v_mfma_f32_32x32x16_bf16 v[80:95], v[144:147], v[40:43], v[80:95]
    ds_read_b64 v[36:37], v26 offset:18432
    ds_read_b64 v[38:39], v26 offset:19456
    s_waitcnt lgkmcnt(6)
    v_mfma_f32_32x32x16_bf16 v[80:95], v[148:151], v[8:11], v[80:95]
    ds_read_b64 v[40:41], v26 offset:18944
    ds_read_b64 v[42:43], v26 offset:19968
    s_waitcnt lgkmcnt(7)
    v_mfma_f32_32x32x16_bf16 v[80:95], v[152:155], v[12:15], v[80:95]
    s_waitcnt vmcnt(4)
    s_barrier
    ds_read_b128 v[8:11], v4 offset:20480
    s_waitcnt lgkmcnt(7)
    v_mfma_f32_32x32x16_bf16 v[80:95], v[156:159], v[16:19], v[80:95]
    ds_read_b128 v[12:15], v4 offset:20992
    s_waitcnt lgkmcnt(7)
    v_mfma_f32_32x32x16_bf16 v[80:95], v[160:163], v[28:31], v[80:95]
    ds_read_b128 v[16:19], v4 offset:21504
    s_waitcnt vmcnt(0)
    ds_read_b64_tr_b16 v[48:49], v23 offset:0
    ds_read_b64_tr_b16 v[50:51], v23 offset:512
    ds_read_b64_tr_b16 v[52:53], v23 offset:2048
    ds_read_b64_tr_b16 v[54:55], v23 offset:2560
    v_xor_b32 v23, 64, v23
    s_waitcnt lgkmcnt(11)
    v_mfma_f32_32x32x16_bf16 v[80:95], v[164:167], v[32:35], v[80:95]
    ds_read_b128 v[28:31], v4 offset:22016
    ds_read_b64_tr_b16 v[56:57], v23 offset:0
    ds_read_b64_tr_b16 v[58:59], v23 offset:512
    ds_read_b64_tr_b16 v[60:61], v23 offset:2048
    ds_read_b64_tr_b16 v[62:63], v23 offset:2560
    s_waitcnt lgkmcnt(14)
    v_mfma_f32_32x32x16_bf16 v[80:95], v[168:171], v[36:39], v[80:95]
    ds_read_b128 v[32:35], v4 offset:22528
    s_waitcnt lgkmcnt(13)
    v_mfma_f32_32x32x16_bf16 v[80:95], v[172:175], v[40:43], v[80:95]
    ds_read_b128 v[36:39], v4 offset:23040
    s_waitcnt lgkmcnt(12)
    v_mfma_f32_32x32x16_bf16 v[80:95], v[176:179], v[8:11], v[80:95]
    s_waitcnt lgkmcnt(2)
    v_cmp_u_f32 s[60:61], v64, v64
    s_lshl_b32 s42, s40, 2
    v_mov_b32 v20, s42
    v_mov_b32 v25, 0
    v_mfma_f32_32x32x16_bf16 v[80:95], v[180:183], v[12:15], v[80:95]
    v_lshlrev_b32 v96, 16, v48
    v_and_b32 v97, 0xffff0000, v48
    v_lshlrev_b32 v98, 16, v49
    v_and_b32 v99, 0xffff0000, v49
    ds_read_b128 v[40:43], v4 offset:23552
    ds_read_b128 v[8:11], v4 offset:24064
    v_mfma_f32_32x32x16_bf16 v[80:95], v[184:187], v[16:19], v[80:95]
    v_lshlrev_b32 v100, 16, v50
    v_and_b32 v101, 0xffff0000, v50
    v_lshlrev_b32 v102, 16, v51
    v_and_b32 v103, 0xffff0000, v51
    v_mfma_f32_32x32x16_bf16 v[80:95], v[188:191], v[28:31], v[80:95]
    v_lshlrev_b32 v104, 16, v52
    v_and_b32 v105, 0xffff0000, v52
    v_lshlrev_b32 v106, 16, v53
    v_and_b32 v107, 0xffff0000, v53
    ds_read_b64 v[12:13], v24 offset:28672
    ds_read_b64 v[14:15], v24 offset:29696
    ds_read_b64 v[16:17], v24 offset:29184
    ds_read_b64 v[18:19], v24 offset:30208
    s_waitcnt lgkmcnt(6)
    v_mfma_f32_32x32x16_bf16 v[80:95], v[192:195], v[32:35], v[80:95]
    v_lshlrev_b32 v108, 16, v54
    v_and_b32 v109, 0xffff0000, v54
    v_lshlrev_b32 v110, 16, v55
    v_and_b32 v111, 0xffff0000, v55
    v_mfma_f32_32x32x16_bf16 v[80:95], v[196:199], v[36:39], v[80:95]
    v_sub_f32 v160, 1.0, v44
    v_sub_f32 v161, 1.0, v45
    v_mul_f32 v96, v96, v44
    v_mul_f32 v97, v97, v44
    ds_read_b128 v[28:31], v4 offset:30720
    ds_read_b128 v[32:35], v4 offset:31232
    s_waitcnt lgkmcnt(6)
    v_mfma_f32_32x32x16_bf16 v[80:95], v[200:203], v[40:43], v[80:95]
    v_mul_f32 v98, v98, v44
    v_mul_f32 v99, v99, v44
    v_mul_f32 v100, v100, v44
    v_mul_f32 v101, v101, v44
    v_or_b32 v21, 8, v21
    global_load_dwordx2 v[162:163], v21, s[38:39] sc1
    v_mfma_f32_32x32x16_bf16 v[80:95], v[204:207], v[8:11], v[80:95]
    v_mul_f32 v102, v102, v44
    v_mul_f32 v103, v103, v44
    v_mul_f32 v104, v104, v44
    v_mul_f32 v105, v105, v44
    ds_read_b128 v[36:39], v4 offset:31744
    ds_read_b128 v[40:43], v4 offset:32256
    s_waitcnt lgkmcnt(4)
    v_mfma_f32_32x32x16_bf16 v[80:95], v[208:211], v[12:15], v[80:95]
    v_mul_f32 v106, v106, v44
    v_mul_f32 v107, v107, v44
    v_mul_f32 v108, v108, v44
    v_mul_f32 v109, v109, v44
    v_mfma_f32_32x32x16_bf16 v[80:95], v[212:215], v[16:19], v[80:95]
    v_mul_f32 v110, v110, v44
    v_mul_f32 v111, v111, v44
    v_fmac_f32 v96, v64, v160
    v_fmac_f32 v97, v65, v160
    ds_read_b128 v[8:11], v4 offset:32768
    ds_read_b128 v[12:15], v4 offset:33280
    s_waitcnt lgkmcnt(4)
    v_mfma_f32_32x32x16_bf16 v[80:95], v[216:219], v[28:31], v[80:95]
    v_fmac_f32 v98, v66, v160
    v_fmac_f32 v99, v67, v160
    v_cvt_pk_bf16_f32 v128, v96, v97
    v_cvt_pk_bf16_f32 v129, v98, v99
    v_mfma_f32_32x32x16_bf16 v[80:95], v[220:223], v[32:35], v[80:95]
    v_fmac_f32 v100, v68, v160
    v_fmac_f32 v101, v69, v160
    v_fmac_f32 v102, v70, v160
    v_fmac_f32 v103, v71, v160
    ds_read_b128 v[16:19], v4 offset:33792
    ds_read_b128 v[28:31], v4 offset:34304
    s_waitcnt lgkmcnt(4)
    v_mfma_f32_32x32x16_bf16 v[80:95], v[224:227], v[36:39], v[80:95]
    v_cvt_pk_bf16_f32 v130, v100, v101
    v_cvt_pk_bf16_f32 v131, v102, v103
    ds_write_b128 v47, v[128:131] offset:0
    v_fmac_f32 v104, v72, v160
    v_mfma_f32_32x32x16_bf16 v[80:95], v[228:231], v[40:43], v[80:95]
    v_fmac_f32 v105, v73, v160
    v_fmac_f32 v106, v74, v160
    v_fmac_f32 v107, v75, v160
    v_cvt_pk_bf16_f32 v132, v104, v105
    ds_read_b64 v[32:33], v26 offset:38912
    ds_read_b64 v[34:35], v26 offset:39936
    ds_read_b64 v[36:37], v26 offset:39424
    ds_read_b64 v[38:39], v26 offset:40448
    s_waitcnt lgkmcnt(7)
    v_mfma_f32_32x32x16_bf16 v[80:95], v[232:235], v[8:11], v[80:95]
    v_cvt_pk_bf16_f32 v133, v106, v107
    v_fmac_f32 v108, v76, v160
    v_fmac_f32 v109, v77, v160
    v_fmac_f32 v110, v78, v160
    v_fmac_f32 v111, v79, v160
    v_mfma_f32_32x32x16_bf16 v[80:95], v[236:239], v[12:15], v[80:95]
    v_cvt_pk_bf16_f32 v134, v108, v109
    v_cvt_pk_bf16_f32 v135, v110, v111
    ds_write_b128 v47, v[132:135] offset:32
    v_lshlrev_b32 v112, 16, v56
    v_and_b32 v113, 0xffff0000, v56
    s_waitcnt lgkmcnt(6)
    v_mfma_f32_32x32x16_bf16 v[80:95], v[240:243], v[16:19], v[80:95]
    v_lshlrev_b32 v114, 16, v57
    v_and_b32 v115, 0xffff0000, v57
    v_mul_f32 v112, v112, v45
    v_mul_f32 v113, v113, v45
    v_mul_f32 v114, v114, v45
    s_waitcnt lgkmcnt(0)
    s_barrier
    ds_read_b128 v[144:147], v27 offset:0
    ds_read_b128 v[148:151], v27 offset:1088
    v_mfma_f32_32x32x16_bf16 v[80:95], v[244:247], v[28:31], v[80:95]
    v_mul_f32 v115, v115, v45
    v_lshlrev_b32 v116, 16, v58
    v_and_b32 v117, 0xffff0000, v58
    v_lshlrev_b32 v118, 16, v59
    v_and_b32 v119, 0xffff0000, v59
    v_mfma_f32_32x32x16_bf16 v[80:95], v[248:251], v[32:35], v[80:95]
    v_mul_f32 v116, v116, v45
    v_mul_f32 v117, v117, v45
    v_mul_f32 v118, v118, v45
    v_mul_f32 v119, v119, v45
    v_lshlrev_b32 v120, 16, v60
    v_mfma_f32_32x32x16_bf16 v[80:95], v[252:255], v[36:39], v[80:95]
    v_and_b32 v121, 0xffff0000, v60
    v_lshlrev_b32 v122, 16, v61
    v_and_b32 v123, 0xffff0000, v61
    v_mul_f32 v120, v120, v45
    v_mul_f32 v121, v121, v45
    s_waitcnt lgkmcnt(0)
    global_store_dwordx4 v5, v[144:147], s[34:35] sc1
    global_store_dwordx4 v7, v[148:151], s[34:35] sc1
    v_mul_f32 v122, v122, v45
    v_mul_f32 v123, v123, v45
    v_lshlrev_b32 v124, 16, v62
    v_and_b32 v125, 0xffff0000, v62
    v_lshlrev_b32 v126, 16, v63
    v_and_b32 v127, 0xffff0000, v63
    v_mul_f32 v124, v124, v45
    v_mul_f32 v125, v125, v45
    v_mul_f32 v126, v126, v45
    v_mul_f32 v127, v127, v45
    v_fmac_f32 v112, v80, v161
    v_fmac_f32 v113, v81, v161
    v_fmac_f32 v114, v82, v161
    v_fmac_f32 v115, v83, v161
    v_cvt_pk_bf16_f32 v136, v112, v113
    v_cvt_pk_bf16_f32 v137, v114, v115
    v_fmac_f32 v116, v84, v161
    v_fmac_f32 v117, v85, v161
    v_fmac_f32 v118, v86, v161
    v_fmac_f32 v119, v87, v161
    v_cvt_pk_bf16_f32 v138, v116, v117
    v_cvt_pk_bf16_f32 v139, v118, v119
    ds_write_b128 v47, v[136:139] offset:10240
    v_fmac_f32 v120, v88, v161
    v_fmac_f32 v121, v89, v161
    v_fmac_f32 v122, v90, v161
    v_fmac_f32 v123, v91, v161
    v_cvt_pk_bf16_f32 v140, v120, v121
    v_cvt_pk_bf16_f32 v141, v122, v123
    v_fmac_f32 v124, v92, v161
    v_fmac_f32 v125, v93, v161
    v_fmac_f32 v126, v94, v161
    v_fmac_f32 v127, v95, v161
    v_cvt_pk_bf16_f32 v142, v124, v125
    v_cvt_pk_bf16_f32 v143, v126, v127
    ds_write_b128 v47, v[140:143] offset:10272
    v_cmp_u_f32 vcc, v80, v80
    s_nop 0
    s_or_b64 vcc, vcc, s[60:61]
    s_or_b32 s42, vcc_lo, vcc_hi
    v_mov_b32 v6, s42
    ds_write_b32 v20, v6 offset:40000
    s_waitcnt lgkmcnt(0)
    s_barrier
    ds_read_b128 v[152:155], v27 offset:10240
    ds_read_b128 v[156:159], v27 offset:11328
    ds_read_b128 v[8:11], v25 offset:40000
    s_waitcnt lgkmcnt(2)
    global_store_dwordx4 v2, v[152:155], s[34:35] sc1
    s_waitcnt lgkmcnt(1)
    global_store_dwordx4 v3, v[156:159], s[34:35] sc1
    s_waitcnt lgkmcnt(0)
    v_or3_b32 v8, v8, v9, v10
    v_or_b32 v8, v8, v11
    s_nop 0
    v_readfirstlane_b32 s42, v8
    s_mov_b32 s66, 300000
    s_waitcnt vmcnt(4)
F_fchk:
    v_readfirstlane_b32 s44, v162
    v_readfirstlane_b32 s45, v163
    s_cmp_ge_u32 s44, 8
    s_cbranch_scc1 F_fok
    s_sleep 4
    global_load_dwordx2 v[162:163], v21, s[38:39] sc1
    s_waitcnt vmcnt(0)
    s_sub_u32 s66, s66, 1
    s_cmp_lg_u32 s66, 0
    s_cbranch_scc1 F_fchk
F_fok:
    s_or_b32 s42, s42, s45
    s_cmp_eq_u32 s42, 0
    s_cbranch_scc1 F_end
    s_cmp_lg_u32 s25, 0
    s_cbranch_scc1 F_end
    s_mov_b32 s25, 8
    s_waitcnt vmcnt(0)
    s_barrier
    s_branch F_redo
F_end:
    s_endpgm
F_slow:
    s_mov_b32 s66, 300000
poll9:
    global_load_dword v6, v20, s[38:39] sc1
poll9c:
    s_waitcnt vmcnt(0)
    v_cmp_le_u32 vcc, 1, v6
    s_nop 0
    s_and_b32 vcc_lo, vcc_lo, 0xffff
    s_cmp_eq_u32 vcc_lo, 0xffff
    s_cbranch_scc1 poll9d
    s_sleep 5
    s_sub_u32 s66, s66, 1
    s_cmp_lg_u32 s66, 0
    s_cbranch_scc1 poll9
poll9d:
    s_branch F_at
T_exit:
    s_sub_u32 s41, s7, 28
    s_mul_i32 s41, s41, 160
    v_lshrrev_b32 v2, 1, v0
    v_and_b32 v3, 1, v0
    v_add_u32 v2, s41, v2
    v_mul_u32_u24 v2, 1280, v2
    v_lshl_add_u32 v2, v3, 7, v2
    global_load_dword v4, v2, s[30:31]
    v_add_u32 v2, 40960, v2
    s_cmp_lt_u32 s40, 3
    s_cbranch_scc1 T_exit2
    global_load_dword v5, v2, s[30:31]
T_exit2:
    s_endpgm
A_body:
    s_mul_i32 s43, s40, 20352
    s_cmp_eq_u32 s60, 2
    s_cselect_b32 s42, 40704, 0
    s_sub_u32 s61, s43, s42
    s_add_u32 s62, s61, 40704
    s_mul_i32 s63, s60, 3328
    s_add_u32 s63, s63, s62
    s_add_u32 s42, s43, 9600
    s_cmp_eq_u32 s60, 0
    s_cselect_b32 s63, s42, s63
    v_sub_u32 v2, 63, v1
    v_lshlrev_b32 v2, 1, v2
    v_lshl_add_u32 v26, v2, 2, s63
    v_add_u32 v3, 0, v2
    v_bfe_u32 v4, v3, 1, 1
    v_add3_u32 v3, v3, v4, 0
    v_lshrrev_b32 v3, 1, v3
    v_lshl_add_u32 v27, v3, 2, s63
    v_add_u32 v3, 1, v2
    v_bfe_u32 v4, v3, 1, 1
    v_add3_u32 v3, v3, v4, 0
    v_lshrrev_b32 v3, 1, v3
    v_lshl_add_u32 v28, v3, 2, s63
    v_add_u32 v3, 2, v2
    v_bfe_u32 v4, v3, 1, 1
    v_add3_u32 v3, v3, v4, 0
    v_lshrrev_b32 v3, 1, v3
    v_lshl_add_u32 v29, v3, 2, s63
    v_add_u32 v3, 0, v2
    v_bfe_u32 v4, v3, 2, 1
    v_add3_u32 v3, v3, v4, 1
    v_lshrrev_b32 v3, 2, v3
    v_lshl_add_u32 v30, v3, 2, s63
    v_add_u32 v3, 1, v2
    v_bfe_u32 v4, v3, 2, 1
    v_add3_u32 v3, v3, v4, 1
    v_lshrrev_b32 v3, 2, v3
    v_lshl_add_u32 v31, v3, 2, s63
    v_add_u32 v3, 2, v2
    v_bfe_u32 v4, v3, 2, 1
    v_add3_u32 v3, v3, v4, 1
    v_lshrrev_b32 v3, 2, v3
    v_lshl_add_u32 v32, v3, 2, s63
    v_add_u32 v3, 0, v2
    v_bfe_u32 v4, v3, 3, 1
    v_add3_u32 v3, v3, v4, 3
    v_lshrrev_b32 v3, 3, v3
    v_lshl_add_u32 v33, v3, 2, s63
    v_add_u32 v3, 1, v2
    v_bfe_u32 v4, v3, 3, 1
    v_add3_u32 v3, v3, v4, 3
    v_lshrrev_b32 v3, 3, v3
    v_lshl_add_u32 v34, v3, 2, s63
    v_add_u32 v3, 2, v2
    v_bfe_u32 v4, v3, 3, 1
    v_add3_u32 v3, v3, v4, 3
    v_lshrrev_b32 v3, 3, v3
    v_lshl_add_u32 v35, v3, 2, s63
    v_and_b32 v2, 15, v1
    v_lshrrev_b32 v3, 4, v1
    v_sub_u32 v4, 0, v2
    v_and_b32 v4, 3, v4
    v_mul_u32_u24 v5, 2368, v4
    v_add_u32 v6, v2, v4
    v_sub_u32 v6, 112, v6
    v_lshl_add_u32 v6, v3, 3, v6
    v_lshl_add_u32 v5, v6, 1, v5
    v_add3_u32 v36, v5, s61, 16
    v_lshlrev_b32 v5, 2, v3
    v_sub_u32 v5, v2, v5
    s_add_u32 s42, s63, 2152
    v_lshl_add_u32 v176, v5, 3, s42
    v_lshlrev_b32 v5, 5, v2
    v_lshl_add_u32 v6, v3, 4, v5
    s_add_u32 s42, s61, 16288
    v_add_u32 v37, s42, v6
    v_and_b32 v6, 1, v3
    v_lshl_add_u32 v5, v6, 9, v5
    v_lshrrev_b32 v6, 1, v3
    v_lshl_add_u32 v6, v6, 4, v5
    s_mul_i32 s42, s41, 4352
    v_add_u32 v39, s42, v6
    v_and_b32 v2, 31, v1
    v_lshrrev_b32 v3, 5, v1
    v_mul_u32_u24 v4, 272, v2
    v_lshl_add_u32 v4, v3, 4, v4
    v_add_u32 v40, s43, v4
    v_lshlrev_b32 v4, 5, v2
    v_lshl_add_u32 v4, v3, 4, v4
    v_add_u32 v44, s63, v4
    v_cmp_eq_u32 vcc, 0, v3
    v_lshlrev_b32 v4, 4, v2
    v_lshlrev_b32 v5, 3, v2
    v_add_u32 v6, 1024, v4
    v_add_u32 v7, 1536, v5
    v_cndmask_b32 v6, v7, v6, vcc
    v_add_u32 v41, s63, v6
    v_add_u32 v6, 1032, v4
    v_add_u32 v7, 1792, v5
    v_cndmask_b32 v6, v7, v6, vcc
    v_add_u32 v42, s63, v6
    v_lshlrev_b32 v4, 2, v2
    v_lshl_add_u32 v4, v3, 9, v4
    s_add_u32 s42, s63, 2172
    v_add_u32 v43, s42, v4
    v_mov_b32 v2, 0
    v_mov_b32 v3, 0
    s_mov_b32 m0, s61
    s_mov_b64 exec, 15
    ds_write_addtid_b32 v2 offset:16240
    s_mov_b64 exec, -1
    s_mov_b32 m0, s43
    v_mov_b32 v5, 0x3f80
    ds_write_addtid_b32 v5 offset:5712
    v_mov_b32 v80, v2
    v_mov_b32 v81, v2
    v_mov_b32 v82, v2
    v_mov_b32 v83, v2
    v_mov_b32 v84, v2
    v_mov_b32 v85, v2
    v_mov_b32 v86, v2
    v_mov_b32 v87, v2
    v_mov_b32 v88, v2
    v_mov_b32 v89, v2
    v_mov_b32 v90, v2
    v_mov_b32 v91, v2
    v_mov_b32 v92, v2
    v_mov_b32 v93, v2
    v_mov_b32 v94, v2
    v_mov_b32 v95, v2
    s_waitcnt lgkmcnt(0)
    s_bitcmp1_b32 s41, 0
    s_cselect_b32 s46, 0, 16
    s_lshl_b32 s64, s64, s46
    s_lshl_b32 s65, s65, s46
    s_and_b32 s64, s64, 0xffff0000
    s_and_b32 s65, s65, 0xffff0000
    v_mov_b32 v2, 0x3fb8aa3b
    v_mul_f32 v2, s64, v2
    v_exp_f32 v2, v2
    v_cmp_eq_u32 vcc, 0, v1
    v_mov_b32 v3, s65
    v_cvt_pk_bf16_f32 v2, v2, v2
    v_cndmask_b32 v45, 0, v3, vcc
    v_and_b32 v2, 0xffff0000, v2
    s_waitcnt vmcnt(0)
    v_lshlrev_b32 v4, 16, v162
    v_lshlrev_b32 v5, 16, v163
    v_lshlrev_b32 v6, 16, v164
    v_lshlrev_b32 v7, 16, v165
    v_lshlrev_b32 v8, 16, v166
    v_lshlrev_b32 v9, 16, v167
    v_mul_f32 v4, v4, v2
    v_mul_f32 v5, v5, v2
    v_mul_f32 v6, v6, v2
    v_mul_f32 v7, v7, v2
    v_mul_f32 v14, 0x3fb8aa3b, v4
    v_mul_f32 v15, 0.15915494, v5
    v_mul_f32 v10, v8, v6
    v_mul_f32 v11, v9, v6
    v_fma_f32 v16, -v9, v7, v10
    v_fma_f32 v17, v8, v7, v11
    v_and_b32 v4, 0xffff0000, v162
    v_and_b32 v5, 0xffff0000, v163
    v_and_b32 v6, 0xffff0000, v164
    v_and_b32 v7, 0xffff0000, v165
    v_and_b32 v8, 0xffff0000, v166
    v_and_b32 v9, 0xffff0000, v167
    v_mul_f32 v4, v4, v2
    v_mul_f32 v5, v5, v2
    v_mul_f32 v6, v6, v2
    v_mul_f32 v7, v7, v2
    v_mul_f32 v18, 0x3fb8aa3b, v4
    v_mul_f32 v19, 0.15915494, v5
    v_mul_f32 v10, v8, v6
    v_mul_f32 v11, v9, v6
    v_fma_f32 v20, -v9, v7, v10
    v_fma_f32 v21, v8, v7, v11
    v_lshlrev_b32 v4, 16, v168
    v_lshlrev_b32 v5, 16, v169
    v_lshlrev_b32 v6, 16, v170
    v_lshlrev_b32 v7, 16, v171
    v_lshlrev_b32 v8, 16, v172
    v_lshlrev_b32 v9, 16, v173
    v_mul_f32 v4, v4, v2
    v_mul_f32 v5, v5, v2
    v_mul_f32 v6, v6, v2
    v_mul_f32 v7, v7, v2
    v_mul_f32 v22, 0x3fb8aa3b, v4
    v_mul_f32 v23, 0.15915494, v5
    v_mul_f32 v10, v8, v6
    v_mul_f32 v11, v9, v6
    v_fma_f32 v24, -v9, v7, v10
    v_fma_f32 v25, v8, v7, v11
    s_sub_u32 s44, 3, s60
    s_cmp_eq_u32 s60, 2
    s_cbranch_scc0 A_p0
    v_mov_b32 v14, v22
    v_mov_b32 v15, v23
    v_mov_b32 v16, v24
    v_mov_b32 v17, v25
A_p0:
    s_cmp_eq_u32 s60, 0
    s_cselect_b32 s57, 1, 0
    s_cmp_eq_u32 s60, 0
    s_cselect_b32 s46, 0, 128
    s_cselect_b32 s58, 64, 1
    v_mov_b32 v160, s46
    s_mov_b32 s42, 0x41000000
    s_mov_b32 s45, 0x43800000
    v_mul_f32 v2, s42, v14
    v_exp_f32 v4, v14
    v_mul_f32 v6, s45, v14
    v_mul_f32 v3, s42, v15
    v_fract_f32 v5, v15
    v_mul_f32 v7, s45, v15
    v_exp_f32 v2, v2
    v_cos_f32 v46, v5
    v_exp_f32 v6, v6
    v_fract_f32 v3, v3
    v_sin_f32 v47, v5
    v_fract_f32 v7, v7
    v_cos_f32 v48, v3
    v_cos_f32 v52, v7
    v_sin_f32 v49, v3
    v_sin_f32 v53, v7
    s_branch A_pass2
.p2align 3
A_pass:
    v_mul_f32 v2, s42, v14
    v_exp_f32 v4, v14
    s_waitcnt lgkmcnt(7)
    v_mfma_f32_32x32x16_bf16 v[80:95], v[96:99], v[100:103], v[80:95]
    v_mul_f32 v6, s45, v14
    v_mul_f32 v3, s42, v15
    s_waitcnt lgkmcnt(6)
    v_mfma_f32_32x32x16_bf16 v[80:95], v[104:107], v[108:111], v[80:95]
    v_fract_f32 v5, v15
    v_mul_f32 v7, s45, v15
    s_waitcnt lgkmcnt(5)
    v_mfma_f32_32x32x16_bf16 v[80:95], v[112:115], v[116:119], v[80:95]
    v_exp_f32 v2, v2
    v_cos_f32 v46, v5
    s_waitcnt lgkmcnt(4)
    v_mfma_f32_32x32x16_bf16 v[80:95], v[120:123], v[124:127], v[80:95]
    v_exp_f32 v6, v6
    v_fract_f32 v3, v3
    s_waitcnt lgkmcnt(3)
    v_mfma_f32_32x32x16_bf16 v[80:95], v[128:131], v[132:135], v[80:95]
    v_sin_f32 v47, v5
    v_fract_f32 v7, v7
    s_waitcnt lgkmcnt(2)
    v_mfma_f32_32x32x16_bf16 v[80:95], v[136:139], v[140:143], v[80:95]
    v_cos_f32 v48, v3
    v_cos_f32 v52, v7
    s_waitcnt lgkmcnt(1)
    v_mfma_f32_32x32x16_bf16 v[80:95], v[144:147], v[148:151], v[80:95]
    v_sin_f32 v49, v3
    v_sin_f32 v53, v7
    s_waitcnt lgkmcnt(0)
    v_mfma_f32_32x32x16_bf16 v[80:95], v[152:155], v[156:159], v[80:95]
.p2align 3
A_pass2:
    v_mul_f32 v46, v46, v4
    v_mul_f32 v47, v47, v4
    v_mul_f32 v48, v48, v2
    v_mul_f32 v49, v49, v2
    v_mul_f32 v52, v52, v6
    v_mul_f32 v53, v53, v6
    v_mul_f32 v56, v49, v49
    v_mul_f32 v57, v48, v49
    v_mul_f32 v74, v17, v53
    v_mul_f32 v75, v16, v53
    v_fma_f32 v50, v48, v48, -v56
    v_fma_f32 v51, v49, v48, v57
    v_fma_f32 v72, v16, v52, -v74
    v_fma_f32 v73, v17, v52, v75
    v_cvt_pk_bf16_f32 v58, v50, v51
    v_cvt_pk_bf16_f32 v64, v48, v49
    v_cvt_pk_bf16_f32 v70, v16, -v17
    v_cvt_pk_bf16_f32 v76, v72, -v73
    v_mul_f32 v56, v51, v51
    v_mul_f32 v57, v50, v51
    v_mul_f32 v62, v49, v51
    v_mul_f32 v63, v48, v51
    v_mul_f32 v68, v17, v47
    v_mul_f32 v69, v16, v47
    v_mul_f32 v74, v73, v53
    v_mul_f32 v75, v72, v53
    v_fma_f32 v54, v50, v50, -v56
    v_fma_f32 v55, v51, v50, v57
    v_fma_f32 v60, v48, v50, -v62
    v_fma_f32 v61, v49, v50, v63
    v_fma_f32 v66, v16, v46, -v68
    v_fma_f32 v67, v17, v46, v69
    v_fma_f32 v72, v72, v52, -v74
    v_fma_f32 v73, v73, v52, v75
    v_cvt_pk_bf16_f32 v59, v54, v55
    v_cvt_pk_bf16_f32 v65, v60, v61
    v_cvt_pk_bf16_f32 v71, v66, -v67
    v_cvt_pk_bf16_f32 v77, v72, -v73
    ds_write_addtid_b32 v58 offset:6256
    ds_write_addtid_b32 v64 offset:5984
    ds_write_addtid_b32 v70 offset:0
    ds_write_addtid_b32 v76 offset:2176
    ds_write_addtid_b32 v59 offset:6800
    ds_write_addtid_b32 v65 offset:6528
    ds_write_addtid_b32 v71 offset:272
    ds_write_addtid_b32 v77 offset:3264
    v_mul_f32 v56, v55, v51
    v_mul_f32 v57, v54, v51
    v_mul_f32 v62, v61, v51
    v_mul_f32 v63, v60, v51
    v_mul_f32 v68, v67, v47
    v_mul_f32 v69, v66, v47
    v_mul_f32 v74, v73, v53
    v_mul_f32 v75, v72, v53
    v_fma_f32 v54, v54, v50, -v56
    v_fma_f32 v55, v55, v50, v57
    v_fma_f32 v60, v60, v50, -v62
    v_fma_f32 v61, v61, v50, v63
    v_fma_f32 v8, v66, v46, -v68
    v_fma_f32 v9, v67, v46, v69
    v_fma_f32 v72, v72, v52, -v74
    v_fma_f32 v73, v73, v52, v75
    v_cvt_pk_bf16_f32 v58, v54, v55
    v_cvt_pk_bf16_f32 v64, v60, v61
    v_cvt_pk_bf16_f32 v70, v8, -v9
    v_cvt_pk_bf16_f32 v76, v72, -v73
    v_mul_f32 v56, v55, v51
    v_mul_f32 v57, v54, v51
    v_mul_f32 v62, v61, v51
    v_mul_f32 v63, v60, v51
    v_mul_f32 v68, v9, v47
    v_mul_f32 v69, v8, v47
    v_mul_f32 v74, v73, v53
    v_mul_f32 v75, v72, v53
    v_fma_f32 v54, v54, v50, -v56
    v_fma_f32 v55, v55, v50, v57
    v_fma_f32 v60, v60, v50, -v62
    v_fma_f32 v61, v61, v50, v63
    v_fma_f32 v66, v8, v46, -v68
    v_fma_f32 v67, v9, v46, v69
    v_fma_f32 v72, v72, v52, -v74
    v_fma_f32 v73, v73, v52, v75
    v_cvt_pk_bf16_f32 v59, v54, v55
    v_cvt_pk_bf16_f32 v65, v60, v61
    v_cvt_pk_bf16_f32 v71, v66, -v67
    v_cvt_pk_bf16_f32 v77, v72, -v73
    ds_write_addtid_b32 v58 offset:7344
    ds_write_addtid_b32 v64 offset:7072
    ds_write_addtid_b32 v70 offset:544
    ds_write_addtid_b32 v76 offset:3808
    ds_write_addtid_b32 v59 offset:7888
    ds_write_addtid_b32 v65 offset:7616
    ds_write_addtid_b32 v71 offset:816
    ds_write_addtid_b32 v77 offset:4352
    v_mul_f32 v56, v55, v51
    v_mul_f32 v57, v54, v51
    v_mul_f32 v62, v61, v51
    v_mul_f32 v63, v60, v51
    v_mul_f32 v68, v67, v47
    v_mul_f32 v69, v66, v47
    v_mul_f32 v74, v73, v53
    v_mul_f32 v75, v72, v53
    v_fma_f32 v54, v54, v50, -v56
    v_fma_f32 v55, v55, v50, v57
    v_fma_f32 v60, v60, v50, -v62
    v_fma_f32 v61, v61, v50, v63
    v_fma_f32 v10, v66, v46, -v68
    v_fma_f32 v11, v67, v46, v69
    v_fma_f32 v72, v72, v52, -v74
    v_fma_f32 v73, v73, v52, v75
    v_cvt_pk_bf16_f32 v58, v54, v55
    v_cvt_pk_bf16_f32 v64, v60, v61
    v_cvt_pk_bf16_f32 v70, v10, -v11
    v_cvt_pk_bf16_f32 v76, v72, -v73
    v_mul_f32 v56, v55, v51
    v_mul_f32 v57, v54, v51
    v_mul_f32 v62, v61, v51
    v_mul_f32 v63, v60, v51
    v_mul_f32 v68, v11, v47
    v_mul_f32 v69, v10, v47
    v_mul_f32 v74, v73, v53
    v_mul_f32 v75, v72, v53
    v_fma_f32 v54, v54, v50, -v56
    v_fma_f32 v55, v55, v50, v57
    v_fma_f32 v60, v60, v50, -v62
    v_fma_f32 v61, v61, v50, v63
    v_fma_f32 v66, v10, v46, -v68
    v_fma_f32 v67, v11, v46, v69
    v_fma_f32 v72, v72, v52, -v74
    v_fma_f32 v73, v73, v52, v75
    v_cvt_pk_bf16_f32 v59, v54, v55
    v_cvt_pk_bf16_f32 v65, v60, v61
    v_cvt_pk_bf16_f32 v71, v66, -v67
    v_cvt_pk_bf16_f32 v77, v72, -v73
    ds_write_addtid_b32 v58 offset:8432
    ds_write_addtid_b32 v64 offset:8160
    ds_write_addtid_b32 v70 offset:1088
    ds_write_addtid_b32 v76 offset:4624
    ds_write_addtid_b32 v59 offset:8976
    ds_write_addtid_b32 v65 offset:8704
    ds_write_addtid_b32 v71 offset:1360
    ds_write_addtid_b32 v77 offset:4896
    v_mul_f32 v56, v55, v51
    v_mul_f32 v57, v54, v51
    v_mul_f32 v62, v61, v51
    v_mul_f32 v63, v60, v51
    v_mul_f32 v68, v67, v47
    v_mul_f32 v69, v66, v47
    v_mul_f32 v74, v73, v53
    v_mul_f32 v75, v72, v53
    v_fma_f32 v54, v54, v50, -v56
    v_fma_f32 v55, v55, v50, v57
    v_fma_f32 v60, v60, v50, -v62
    v_fma_f32 v61, v61, v50, v63
    v_fma_f32 v12, v66, v46, -v68
    v_fma_f32 v13, v67, v46, v69
    v_fma_f32 v72, v72, v52, -v74
    v_fma_f32 v73, v73, v52, v75
    v_cvt_pk_bf16_f32 v58, v54, v55
    v_cvt_pk_bf16_f32 v64, v60, v61
    v_cvt_pk_bf16_f32 v70, v12, -v13
    v_cvt_pk_bf16_f32 v76, v72, -v73
    v_mul_f32 v56, v55, v51
    v_mul_f32 v57, v54, v51
    v_mul_f32 v62, v61, v51
    v_mul_f32 v63, v60, v51
    v_mul_f32 v68, v13, v47
    v_mul_f32 v69, v12, v47
    v_mul_f32 v74, v73, v53
    v_mul_f32 v75, v72, v53
    v_fma_f32 v54, v54, v50, -v56
    v_fma_f32 v55, v55, v50, v57
    v_fma_f32 v60, v60, v50, -v62
    v_fma_f32 v61, v61, v50, v63
    v_fma_f32 v66, v12, v46, -v68
    v_fma_f32 v67, v13, v46, v69
    v_fma_f32 v72, v72, v52, -v74
    v_fma_f32 v73, v73, v52, v75
    v_cvt_pk_bf16_f32 v59, v54, v55
    v_cvt_pk_bf16_f32 v65, v60, v61
    v_cvt_pk_bf16_f32 v71, v66, -v67
    v_cvt_pk_bf16_f32 v77, v72, -v73
    ds_write_addtid_b32 v58 offset:9520
    ds_write_addtid_b32 v64 offset:9248
    ds_write_addtid_b32 v70 offset:1632
    ds_write_addtid_b32 v76 offset:5168
    ds_write_addtid_b32 v59 offset:10064
    ds_write_addtid_b32 v65 offset:9792
    ds_write_addtid_b32 v71 offset:1904
    ds_write_addtid_b32 v77 offset:5440
    v_mul_f32 v56, v55, v51
    v_mul_f32 v57, v54, v51
    v_mul_f32 v62, v61, v51
    v_mul_f32 v63, v60, v51
    v_mul_f32 v68, v11, v53
    v_mul_f32 v69, v10, v53
    v_mul_f32 v74, v9, v53
    v_mul_f32 v75, v8, v53
    v_fma_f32 v54, v54, v50, -v56
    v_fma_f32 v55, v55, v50, v57
    v_fma_f32 v60, v60, v50, -v62
    v_fma_f32 v61, v61, v50, v63
    v_fma_f32 v66, v10, v52, -v68
    v_fma_f32 v67, v11, v52, v69
    v_fma_f32 v72, v8, v52, -v74
    v_fma_f32 v73, v9, v52, v75
    v_cvt_pk_bf16_f32 v58, v54, v55
    v_cvt_pk_bf16_f32 v64, v60, v61
    v_cvt_pk_bf16_f32 v70, v66, -v67
    v_cvt_pk_bf16_f32 v76, v72, -v73
    v_mul_f32 v56, v55, v51
    v_mul_f32 v57, v54, v51
    v_mul_f32 v62, v61, v51
    v_mul_f32 v63, v60, v51
    v_mul_f32 v68, v67, v53
    v_mul_f32 v69, v66, v53
    v_mul_f32 v74, v13, v53
    v_mul_f32 v75, v12, v53
    v_fma_f32 v54, v54, v50, -v56
    v_fma_f32 v55, v55, v50, v57
    v_fma_f32 v60, v60, v50, -v62
    v_fma_f32 v61, v61, v50, v63
    v_fma_f32 v66, v66, v52, -v68
    v_fma_f32 v67, v67, v52, v69
    v_fma_f32 v72, v12, v52, -v74
    v_fma_f32 v73, v13, v52, v75
    v_cvt_pk_bf16_f32 v59, v54, v55
    v_cvt_pk_bf16_f32 v65, v60, v61
    v_cvt_pk_bf16_f32 v71, v66, -v67
    v_cvt_pk_bf16_f32 v77, v72, -v73
    ds_write_addtid_b32 v58 offset:10608
    ds_write_addtid_b32 v64 offset:10336
    ds_write_addtid_b32 v70 offset:2720
    ds_write_addtid_b32 v76 offset:2448
    ds_write_addtid_b32 v59 offset:11152
    ds_write_addtid_b32 v65 offset:10880
    ds_write_addtid_b32 v71 offset:3536
    ds_write_addtid_b32 v77 offset:2992
    v_mul_f32 v56, v55, v51
    v_mul_f32 v57, v54, v51
    v_mul_f32 v62, v61, v51
    v_mul_f32 v63, v60, v51
    v_mul_f32 v68, v67, v53
    v_mul_f32 v69, v66, v53
    v_fma_f32 v54, v54, v50, -v56
    v_fma_f32 v55, v55, v50, v57
    v_fma_f32 v60, v60, v50, -v62
    v_fma_f32 v61, v61, v50, v63
    v_fma_f32 v66, v66, v52, -v68
    v_fma_f32 v67, v67, v52, v69
    v_cvt_pk_bf16_f32 v58, v54, v55
    v_cvt_pk_bf16_f32 v64, v60, v61
    v_cvt_pk_bf16_f32 v70, v66, -v67
    v_mul_f32 v56, v55, v51
    v_mul_f32 v57, v54, v51
    v_mul_f32 v62, v61, v51
    v_mul_f32 v63, v60, v51
    v_fma_f32 v54, v54, v50, -v56
    v_fma_f32 v55, v55, v50, v57
    v_fma_f32 v60, v60, v50, -v62
    v_fma_f32 v61, v61, v50, v63
    v_cvt_pk_bf16_f32 v59, v54, v55
    v_cvt_pk_bf16_f32 v65, v60, v61
    ds_write_addtid_b32 v58 offset:11696
    ds_write_addtid_b32 v64 offset:11424
    ds_write_addtid_b32 v70 offset:4080
    ds_write_addtid_b32 v59 offset:12240
    ds_write_addtid_b32 v65 offset:11968
    v_mul_f32 v56, v55, v51
    v_mul_f32 v57, v54, v51
    v_mul_f32 v62, v61, v51
    v_mul_f32 v63, v60, v51
    v_fma_f32 v54, v54, v50, -v56
    v_fma_f32 v55, v55, v50, v57
    v_fma_f32 v60, v60, v50, -v62
    v_fma_f32 v61, v61, v50, v63
    v_cvt_pk_bf16_f32 v58, v54, v55
    v_cvt_pk_bf16_f32 v64, v60, v61
    ds_read_b128 v[96:99], v40 offset:0
    ds_read_b128 v[104:107], v40 offset:32
    v_mul_f32 v56, v55, v51
    v_mul_f32 v57, v54, v51
    v_mul_f32 v62, v61, v51
    v_mul_f32 v63, v60, v51
    v_fma_f32 v54, v54, v50, -v56
    v_fma_f32 v55, v55, v50, v57
    v_fma_f32 v60, v60, v50, -v62
    v_fma_f32 v61, v61, v50, v63
    v_cvt_pk_bf16_f32 v59, v54, v55
    v_cvt_pk_bf16_f32 v65, v60, v61
    ds_write_addtid_b32 v58 offset:12784
    ds_write_addtid_b32 v64 offset:12512
    ds_write_addtid_b32 v59 offset:13328
    ds_write_addtid_b32 v65 offset:13056
    ds_read_b128 v[112:115], v40 offset:64
    ds_read_b128 v[120:123], v40 offset:96
    v_mul_f32 v56, v55, v51
    v_mul_f32 v57, v54, v51
    v_mul_f32 v62, v61, v51
    v_mul_f32 v63, v60, v51
    v_fma_f32 v54, v54, v50, -v56
    v_fma_f32 v55, v55, v50, v57
    v_fma_f32 v60, v60, v50, -v62
    v_fma_f32 v61, v61, v50, v63
    v_cvt_pk_bf16_f32 v58, v54, v55
    v_cvt_pk_bf16_f32 v64, v60, v61
    ds_read_b128 v[128:131], v40 offset:128
    ds_read_b128 v[136:139], v40 offset:160
    v_mul_f32 v62, v61, v51
    v_mul_f32 v63, v60, v51
    v_fma_f32 v60, v60, v50, -v62
    v_fma_f32 v61, v61, v50, v63
    v_cvt_pk_bf16_f32 v65, v60, v61
    ds_write_addtid_b32 v58 offset:13872
    ds_write_addtid_b32 v64 offset:13600
    ds_write_addtid_b32 v65 offset:14144
    ds_read_b128 v[144:147], v40 offset:192
    ds_read_b128 v[152:155], v40 offset:224
    ds_read_b128 v[100:103], v40 offset:5712
    v_mov_b32 v14, v18
    v_mov_b32 v15, v19
    ds_read_b128 v[108:111], v40 offset:5744
    v_mov_b32 v16, v20
    v_mov_b32 v17, v21
    ds_read_b128 v[116:119], v40 offset:5776
    v_mov_b32 v18, v22
    v_mov_b32 v19, v23
    ds_read_b128 v[124:127], v40 offset:5808
    v_mov_b32 v20, v24
    v_mov_b32 v21, v25
    ds_read_b128 v[132:135], v40 offset:5840
    ds_read_b128 v[140:143], v40 offset:5872
    ds_read_b128 v[148:151], v40 offset:5904
    ds_read_b128 v[156:159], v40 offset:5936
    s_sub_u32 s44, s44, 1
    s_cmp_lg_u32 s44, 0
    s_cbranch_scc1 A_pass
A_postpass:
A_nofl:
    v_and_b32 v2, 15, v1
    v_lshrrev_b32 v3, 4, v1
    v_lshlrev_b32 v3, 3, v3
    s_mov_b32 s46, 0x8001
    s_movk_i32 s47, 0x3f80
    v_mov_b32 v4, 4064
    v_lshlrev_b32 v4, v2, v4
    v_lshrrev_b32 v4, v3, v4
    v_bfe_u32 v180, v4, 0, 2
    v_mul_u32_u24 v180, s46, v180
    v_and_b32 v180, 0x10001, v180
    v_mul_u32_u24 v180, s47, v180
    v_bfe_u32 v181, v4, 2, 2
    v_mul_u32_u24 v181, s46, v181
    v_and_b32 v181, 0x10001, v181
    v_mul_u32_u24 v181, s47, v181
    v_bfe_u32 v182, v4, 4, 2
    v_mul_u32_u24 v182, s46, v182
    v_and_b32 v182, 0x10001, v182
    v_mul_u32_u24 v182, s47, v182
    v_bfe_u32 v183, v4, 6, 2
    v_mul_u32_u24 v183, s46, v183
    v_and_b32 v183, 0x10001, v183
    v_mul_u32_u24 v183, s47, v183
    v_mov_b32 v4, 8176
    v_lshlrev_b32 v4, v2, v4
    v_lshrrev_b32 v4, v3, v4
    v_bfe_u32 v184, v4, 0, 2
    v_mul_u32_u24 v184, s46, v184
    v_and_b32 v184, 0x10001, v184
    v_mul_u32_u24 v184, s47, v184
    v_bfe_u32 v185, v4, 2, 2
    v_mul_u32_u24 v185, s46, v185
    v_and_b32 v185, 0x10001, v185
    v_mul_u32_u24 v185, s47, v185
    v_bfe_u32 v186, v4, 4, 2
    v_mul_u32_u24 v186, s46, v186
    v_and_b32 v186, 0x10001, v186
    v_mul_u32_u24 v186, s47, v186
    v_bfe_u32 v187, v4, 6, 2
    v_mul_u32_u24 v187, s46, v187
    v_and_b32 v187, 0x10001, v187
    v_mul_u32_u24 v187, s47, v187
    s_cmp_ge_u32 s2, 384
    s_cbranch_scc1 A_nb0
    s_cmp_eq_u32 s60, 1
    s_cbranch_scc0 A_nb0
    s_barrier
A_nb0:
    s_waitcnt lgkmcnt(7)
    v_mfma_f32_32x32x16_bf16 v[80:95], v[96:99], v[100:103], v[80:95]
    s_waitcnt lgkmcnt(6)
    v_mfma_f32_32x32x16_bf16 v[80:95], v[104:107], v[108:111], v[80:95]
    s_waitcnt lgkmcnt(5)
    v_mfma_f32_32x32x16_bf16 v[80:95], v[112:115], v[116:119], v[80:95]
    s_waitcnt lgkmcnt(4)
    v_mfma_f32_32x32x16_bf16 v[80:95], v[120:123], v[124:127], v[80:95]
    s_waitcnt lgkmcnt(3)
    v_mfma_f32_32x32x16_bf16 v[80:95], v[128:131], v[132:135], v[80:95]
    s_waitcnt lgkmcnt(2)
    v_mfma_f32_32x32x16_bf16 v[80:95], v[136:139], v[140:143], v[80:95]
    s_waitcnt lgkmcnt(1)
    v_mfma_f32_32x32x16_bf16 v[80:95], v[144:147], v[148:151], v[80:95]
    s_waitcnt lgkmcnt(0)
    v_mfma_f32_32x32x16_bf16 v[80:95], v[152:155], v[156:159], v[80:95]
    s_mov_b32 s48, s38
    s_and_b32 s49, s39, 0xffff
    s_mov_b32 s50, 12582912
    s_mov_b32 s51, 0x20000
    v_lshlrev_b32 v7, 4, v1
    s_mul_i32 s59, s41, 4352
    s_add_u32 s59, s59, 9437184
    s_nop 3
    s_cmp_eq_u32 s60, 0
    s_cbranch_scc1 A_nox
    s_cmp_eq_u32 s60, 1
    s_cselect_b32 s46, 3072, 0
    s_sub_u32 s47, 3072, s46
    s_add_u32 s46, s46, 11392
    s_add_u32 s47, s47, 11392
    s_add_u32 s46, s46, s62
    s_add_u32 s47, s47, s62
    v_lshl_add_u32 v4, v1, 4, s46
    v_lshl_add_u32 v5, v1, 4, s47
    ds_write_b128 v4, v[80:83] offset:0
    ds_write_b128 v4, v[84:87] offset:1024
    ds_write_b128 v4, v[88:91] offset:2048
    s_cmp_eq_u32 s60, 2
    s_cbranch_scc0 A_nb00
    s_cmp_eq_u32 s40, 2
    s_cbranch_scc0 A_nothrb
    s_mov_b64 exec, 1
    s_mov_b32 s66, 48
poll10:
    global_load_dword v6, v175, s[38:39] sc1
poll10c:
    s_waitcnt vmcnt(0)
    v_cmp_ne_u32 vcc, v174, v6
    s_nop 0
    s_and_b32 vcc_lo, vcc_lo, 1
    s_cmp_eq_u32 vcc_lo, 1
    s_cbranch_scc1 poll10d
    s_sleep 4
    s_sub_u32 s66, s66, 1
    s_cmp_lg_u32 s66, 0
    s_cbranch_scc1 poll10
poll10d:
    s_mov_b64 exec, -1
A_nothrb:
    s_cmp_ge_u32 s2, 384
    s_cbranch_scc1 A_nb00
    s_barrier
A_nb00:
    s_waitcnt lgkmcnt(0)
    s_barrier
    s_cmp_lt_u32 s2, 384
    s_cbranch_scc1 A_nopr
    s_setprio 3
A_nopr:
    s_cmp_eq_u32 s60, 2
    s_cbranch_scc0 A_ue
    global_load_dword v161, v160, s[36:37] sc1
A_ue:
    ds_read_b128 v[96:99], v5 offset:0
    ds_read_b128 v[100:103], v5 offset:1024
    ds_read_b128 v[104:107], v5 offset:2048
    s_waitcnt lgkmcnt(2)
    v_add_f32 v80, v80, v96
    v_add_f32 v81, v81, v97
    v_add_f32 v82, v82, v98
    v_add_f32 v83, v83, v99
    s_waitcnt lgkmcnt(1)
    v_add_f32 v84, v84, v100
    v_add_f32 v85, v85, v101
    v_add_f32 v86, v86, v102
    v_add_f32 v87, v87, v103
    s_waitcnt lgkmcnt(0)
    v_add_f32 v88, v88, v104
    v_add_f32 v89, v89, v105
    v_add_f32 v90, v90, v106
    v_add_f32 v91, v91, v107
A_nox:
    v_add_f32 v80, v80, v45
    ds_write_b128 v44, v[80:83]
    ds_write_b64 v41, v[84:85]
    ds_write_b64 v42, v[86:87]
    ds_write_b32 v43, v88 offset:0
    ds_write_b32 v43, v89 offset:128
    ds_write_b32 v43, v90 offset:256
    ds_write_b32 v43, v91 offset:384
    v_cmp_eq_u32 vcc, 0, v1
    s_add_u32 m0, s63, 2048
    s_nop 0
    v_cndmask_b32 v2, 0, v88, vcc
    s_mov_b32 exec_hi, 0
    ds_write_addtid_b32 v2
    s_mov_b32 exec_hi, -1
    s_cmp_eq_u32 s60, 2
    s_cbranch_scc0 A_ue2
    s_waitcnt vmcnt(0)
    v_readfirstlane_b32 s46, v161
    s_nop 0
    s_cmp_ge_u32 s46, 1
    s_cbranch_scc1 A_ue1
    s_mov_b32 s66, 300000
poll11:
    global_load_dword v161, v160, s[36:37] sc1
poll11c:
    s_waitcnt vmcnt(0)
    v_cmp_le_u32 vcc, s58, v161
    s_nop 0
    s_and_b32 vcc_lo, vcc_lo, 1
    s_cmp_eq_u32 vcc_lo, 1
    s_cbranch_scc1 poll11d
    s_sleep 8
    s_sub_u32 s66, s66, 1
    s_cmp_lg_u32 s66, 0
    s_cbranch_scc1 poll11
poll11d:
A_ue1:
    s_add_u32 m0, s61, 16256
    s_nop 0
    buffer_load_dwordx4 v7, s[48:51], s59 offen sc1 lds
    buffer_load_dwordx4 v7, s[48:51], s59 offen offset:1024 sc1 lds
    buffer_load_dwordx4 v7, s[48:51], s59 offen offset:2048 sc1 lds
    buffer_load_dwordx4 v7, s[48:51], s59 offen offset:3072 sc1 lds
A_ue2:
    s_add_u32 m0, s61, 12
    s_cmp_eq_u32 s60, 2
    s_cbranch_scc1 A_gx
    ds_read_b32 v108, v30 offset:1536
    ds_read_b32 v109, v31 offset:1536
    ds_read_b32 v110, v32 offset:1536
    ds_read_b32 v111, v30 offset:1664
    ds_read_b32 v112, v31 offset:1664
    ds_read_b32 v113, v32 offset:1664
    ds_read_b32 v114, v30 offset:1792
    ds_read_b32 v115, v31 offset:1792
    ds_read_b32 v116, v32 offset:1792
    ds_read_b32 v117, v30 offset:1920
    ds_read_b32 v118, v31 offset:1920
    ds_read_b32 v119, v32 offset:1920
    ds_read_b32 v120, v33 offset:2048
    ds_read_b32 v121, v34 offset:2048
    ds_read_b32 v122, v35 offset:2048
    s_waitcnt lgkmcnt(12)
    v_cvt_pk_bf16_f32 v50, v110, v109
    v_cvt_pk_bf16_f32 v66, v109, v108
    s_waitcnt lgkmcnt(9)
    v_cvt_pk_bf16_f32 v51, v113, v112
    v_cvt_pk_bf16_f32 v67, v112, v111
    s_waitcnt lgkmcnt(6)
    v_cvt_pk_bf16_f32 v52, v116, v115
    v_cvt_pk_bf16_f32 v68, v115, v114
    s_waitcnt lgkmcnt(3)
    v_cvt_pk_bf16_f32 v53, v119, v118
    v_cvt_pk_bf16_f32 v69, v118, v117
    s_waitcnt lgkmcnt(0)
    v_cvt_pk_bf16_f32 v54, v122, v121
    v_cvt_pk_bf16_f32 v70, v121, v120
    s_cmp_eq_u32 s60, 1
    s_cbranch_scc1 A_wy
    s_cmp_eq_u32 s60, 1
    s_cbranch_scc1 A_wy
A_gx:
    ds_read_b32 v96, v26 offset:0
    ds_read_b32 v97, v26 offset:4
    ds_read_b32 v98, v26 offset:8
    ds_read_b32 v99, v26 offset:512
    ds_read_b32 v100, v26 offset:516
    ds_read_b32 v101, v26 offset:520
    ds_read_b32 v102, v27 offset:1024
    ds_read_b32 v103, v28 offset:1024
    ds_read_b32 v104, v29 offset:1024
    ds_read_b32 v105, v27 offset:1280
    ds_read_b32 v106, v28 offset:1280
    ds_read_b32 v107, v29 offset:1280
    s_waitcnt lgkmcnt(9)
    v_cvt_pk_bf16_f32 v46, v98, v97
    v_cvt_pk_bf16_f32 v62, v97, v96
    s_waitcnt lgkmcnt(6)
    v_cvt_pk_bf16_f32 v47, v101, v100
    v_cvt_pk_bf16_f32 v63, v100, v99
    s_waitcnt lgkmcnt(3)
    v_cvt_pk_bf16_f32 v48, v104, v103
    v_cvt_pk_bf16_f32 v64, v103, v102
    s_waitcnt lgkmcnt(0)
    v_cvt_pk_bf16_f32 v49, v107, v106
    v_cvt_pk_bf16_f32 v65, v106, v105
    v_cmp_eq_u32 vcc, 0, v1
    v_cvt_pk_bf16_f32 v2, v80, 0
    v_mov_b32 v3, 0
    v_cndmask_b32 v2, 0, v2, vcc
    ds_write_addtid_b32 v46 offset:2052
    ds_write_addtid_b32 v62 offset:4420
    ds_write_addtid_b32 v46 offset:6784
    ds_write_addtid_b32 v62 offset:9152
    ds_write_addtid_b32 v47 offset:1796
    ds_write_addtid_b32 v63 offset:4164
    ds_write_addtid_b32 v47 offset:6528
    ds_write_addtid_b32 v63 offset:8896
    ds_write_addtid_b32 v48 offset:1540
    ds_write_addtid_b32 v64 offset:3908
    ds_write_addtid_b32 v48 offset:6272
    ds_write_addtid_b32 v64 offset:8640
    ds_write_addtid_b32 v49 offset:1284
    ds_write_addtid_b32 v65 offset:3652
    ds_write_addtid_b32 v49 offset:6016
    ds_write_addtid_b32 v65 offset:8384
    s_mov_b64 exec, 0xff
    ds_write_addtid_b32 v2 offset:2308
    ds_write_addtid_b32 v3 offset:4676
    ds_write_addtid_b32 v2 offset:7040
    ds_write_addtid_b32 v3 offset:9408
    s_mov_b64 exec, -1
    s_cmp_eq_u32 s60, 2
    s_cbranch_scc1 A_wd
A_wy:
    ds_write_addtid_b32 v50 offset:1028
    ds_write_addtid_b32 v66 offset:3396
    ds_write_addtid_b32 v50 offset:5760
    ds_write_addtid_b32 v66 offset:8128
    ds_write_addtid_b32 v51 offset:772
    ds_write_addtid_b32 v67 offset:3140
    ds_write_addtid_b32 v51 offset:5504
    ds_write_addtid_b32 v67 offset:7872
    ds_write_addtid_b32 v52 offset:516
    ds_write_addtid_b32 v68 offset:2884
    ds_write_addtid_b32 v52 offset:5248
    ds_write_addtid_b32 v68 offset:7616
    ds_write_addtid_b32 v53 offset:260
    ds_write_addtid_b32 v69 offset:2628
    ds_write_addtid_b32 v53 offset:4992
    ds_write_addtid_b32 v69 offset:7360
    ds_write_addtid_b32 v54 offset:4
    ds_write_addtid_b32 v70 offset:2372
    ds_write_addtid_b32 v54 offset:4736
    ds_write_addtid_b32 v70 offset:7104
A_wd:
    s_cmp_ge_u32 s2, 448
    s_cbranch_scc0 A_uf4
    s_mov_b32 s66, 300000
poll12:
    global_load_dword v161, v160, s[36:37] sc1
poll12c:
    s_waitcnt vmcnt(0)
    v_cmp_le_u32 vcc, s58, v161
    s_nop 0
    s_and_b32 vcc_lo, vcc_lo, 1
    s_cmp_eq_u32 vcc_lo, 1
    s_cbranch_scc1 poll12d
    s_sleep 16
    s_sub_u32 s66, s66, 1
    s_cmp_lg_u32 s66, 0
    s_cbranch_scc1 poll12
poll12d:
    s_add_u32 m0, s61, 16256
    s_nop 0
    buffer_load_dwordx4 v7, s[48:51], s59 offen sc1 lds
    buffer_load_dwordx4 v7, s[48:51], s59 offen offset:1024 sc1 lds
    buffer_load_dwordx4 v7, s[48:51], s59 offen offset:2048 sc1 lds
    buffer_load_dwordx4 v7, s[48:51], s59 offen offset:3072 sc1 lds
A_uf4:
    ds_read_b64 v[96:97], v176 offset:24
    ds_read_b64 v[98:99], v176 offset:16
    ds_read_b64 v[100:101], v176 offset:8
    ds_read_b64 v[102:103], v176 offset:0
    ds_read_b64 v[104:105], v176 offset:152
    ds_read_b64 v[106:107], v176 offset:144
    ds_read_b64 v[108:109], v176 offset:136
    ds_read_b64 v[110:111], v176 offset:128
    ds_read_b64 v[112:113], v176 offset:280
    ds_read_b64 v[114:115], v176 offset:272
    ds_read_b64 v[116:117], v176 offset:264
    ds_read_b64 v[118:119], v176 offset:256
    ds_read_b64 v[120:121], v176 offset:408
    ds_read_b64 v[122:123], v176 offset:400
    ds_read_b64 v[124:125], v176 offset:392
    ds_read_b64 v[126:127], v176 offset:384
    s_waitcnt lgkmcnt(12)
    v_cvt_pk_bf16_f32 v188, v96, v98
    v_cvt_pk_bf16_f32 v189, v100, v102
    v_cvt_pk_bf16_f32 v190, v97, v99
    v_cvt_pk_bf16_f32 v191, v101, v103
    s_waitcnt lgkmcnt(8)
    v_cvt_pk_bf16_f32 v192, v104, v106
    v_cvt_pk_bf16_f32 v193, v108, v110
    v_cvt_pk_bf16_f32 v194, v105, v107
    v_cvt_pk_bf16_f32 v195, v109, v111
    s_waitcnt lgkmcnt(4)
    v_cvt_pk_bf16_f32 v196, v112, v114
    v_cvt_pk_bf16_f32 v197, v116, v118
    v_cvt_pk_bf16_f32 v198, v113, v115
    v_cvt_pk_bf16_f32 v199, v117, v119
    s_waitcnt lgkmcnt(0)
    v_cvt_pk_bf16_f32 v200, v120, v122
    v_cvt_pk_bf16_f32 v201, v124, v126
    v_cvt_pk_bf16_f32 v202, v121, v123
    v_cvt_pk_bf16_f32 v203, v125, v127
    s_add_u32 s42, s61, 16240
    s_waitcnt vmcnt(0) lgkmcnt(0)
    s_cmp_eq_u32 s60, 0
    s_cbranch_scc0 A_nb3
    s_cmp_eq_u32 s40, 2
    s_cbranch_scc0 A_nothrc
    s_mov_b64 exec, 1
    s_mov_b32 s66, 48
poll13:
    global_load_dword v6, v175, s[38:39] sc1
poll13c:
    s_waitcnt vmcnt(0)
    v_cmp_ne_u32 vcc, v174, v6
    s_nop 0
    s_and_b32 vcc_lo, vcc_lo, 1
    s_cmp_eq_u32 vcc_lo, 1
    s_cbranch_scc1 poll13d
    s_sleep 4
    s_sub_u32 s66, s66, 1
    s_cmp_lg_u32 s66, 0
    s_cbranch_scc1 poll13
poll13d:
    s_mov_b64 exec, -1
A_nothrc:
A_nb3:
    s_setprio 0
    s_barrier
A_nb2:
    s_cmp_eq_u32 s60, 2
    s_cbranch_scc0 A_c0
    ds_read_b64 v[96:97], v36 offset:1792
    ds_read_b64 v[98:99], v36 offset:1800
    ds_read_b128 v[52:55], v37 offset:3264
    ds_read_b128 v[48:51], v37 offset:2752
    ds_read_b128 v[44:47], v37 offset:2240
    ds_read_b128 v[72:75], v37 offset:1728
    ds_read_b128 v[68:71], v37 offset:1216
    ds_read_b128 v[64:67], v37 offset:704
    ds_read_b128 v[60:63], v37 offset:192
    v_subrev_u32 v38, 320, v37
    v_max_i32 v38, s42, v38
    ds_read_b128 v[56:59], v38
    ds_read_b64 v[100:101], v36 offset:1280
    ds_read_b64 v[102:103], v36 offset:1288
    ds_read_b64 v[104:105], v36 offset:768
    ds_read_b64 v[106:107], v36 offset:776
    ds_read_b64 v[108:109], v36 offset:256
    ds_read_b64 v[110:111], v36 offset:264
    v_mov_b32 v128, 0
    v_mov_b32 v129, 0
    v_mov_b32 v130, 0
    v_mov_b32 v131, 0
    v_mov_b32 v132, 0
    v_mov_b32 v133, 0
    v_mov_b32 v134, 0
    v_mov_b32 v135, 0
    v_mov_b32 v136, 0
    v_mov_b32 v137, 0
    v_mov_b32 v138, 0
    v_mov_b32 v139, 0
    v_mov_b32 v140, 0
    v_mov_b32 v141, 0
    v_mov_b32 v142, 0
    v_mov_b32 v143, 0
    v_mov_b32 v144, 0
    v_mov_b32 v145, 0
    v_mov_b32 v146, 0
    v_mov_b32 v147, 0
    v_mov_b32 v148, 0
    v_mov_b32 v149, 0
    v_mov_b32 v150, 0
    v_mov_b32 v151, 0
    v_mov_b32 v152, 0
    v_mov_b32 v153, 0
    v_mov_b32 v154, 0
    v_mov_b32 v155, 0
    v_mov_b32 v156, 0
    v_mov_b32 v157, 0
    v_mov_b32 v158, 0
    v_mov_b32 v159, 0
    s_waitcnt lgkmcnt(0)
    s_branch A_c4
A_c0:
    ds_read_b64 v[96:97], v36 offset:2048
    ds_read_b64 v[98:99], v36 offset:2056
    ds_read_b128 v[52:55], v37 offset:3520
    ds_read_b128 v[48:51], v37 offset:3008
    ds_read_b128 v[44:47], v37 offset:2496
    ds_read_b128 v[72:75], v37 offset:1984
    ds_read_b128 v[68:71], v37 offset:1472
    ds_read_b128 v[64:67], v37 offset:960
    ds_read_b128 v[60:63], v37 offset:448
    v_subrev_u32 v38, 64, v37
    v_max_i32 v38, s42, v38
    ds_read_b128 v[56:59], v38
    ds_read_b64 v[100:101], v36 offset:1536
    ds_read_b64 v[102:103], v36 offset:1544
    ds_read_b64 v[104:105], v36 offset:1024
    ds_read_b64 v[106:107], v36 offset:1032
    ds_read_b64 v[108:109], v36 offset:512
    ds_read_b64 v[110:111], v36 offset:520
    ds_read_b64 v[14:15], v36 offset:0
    ds_read_b64 v[16:17], v36 offset:8
    s_waitcnt lgkmcnt(15)
    v_mfma_f32_16x16x32_bf16 v[156:159], v[96:99], v[52:55], 0
    ds_read_b128 v[52:55], v37 offset:3456
    s_waitcnt lgkmcnt(15)
    v_mfma_f32_16x16x32_bf16 v[152:155], v[96:99], v[48:51], 0
    ds_read_b64 v[112:113], v36 offset:1984
    s_waitcnt lgkmcnt(15)
    v_mfma_f32_16x16x32_bf16 v[148:151], v[96:99], v[44:47], 0
    ds_read_b64 v[114:115], v36 offset:1992
    s_waitcnt lgkmcnt(15)
    v_mfma_f32_16x16x32_bf16 v[144:147], v[96:99], v[72:75], 0
    ds_read_b128 v[92:95], v37 offset:1920
    s_waitcnt lgkmcnt(15)
    v_mfma_f32_16x16x32_bf16 v[140:143], v[96:99], v[68:71], 0
    ds_read_b128 v[88:91], v37 offset:1408
    s_waitcnt lgkmcnt(15)
    v_mfma_f32_16x16x32_bf16 v[136:139], v[96:99], v[64:67], 0
    ds_read_b128 v[84:87], v37 offset:896
    s_waitcnt lgkmcnt(15)
    v_mfma_f32_16x16x32_bf16 v[132:135], v[96:99], v[60:63], 0
    ds_read_b128 v[80:83], v37 offset:384
    s_waitcnt lgkmcnt(15)
    v_mfma_f32_16x16x32_bf16 v[128:131], v[96:99], v[56:59], 0
    v_subrev_u32 v38, 128, v37
    s_waitcnt lgkmcnt(13)
    v_mfma_f32_16x16x32_bf16 v[156:159], v[100:103], v[48:51], v[156:159]
    ds_read_b128 v[48:51], v37 offset:2944
    v_mfma_f32_16x16x32_bf16 v[152:155], v[100:103], v[44:47], v[152:155]
    v_max_i32 v38, s42, v38
    v_mfma_f32_16x16x32_bf16 v[148:151], v[100:103], v[72:75], v[148:151]
    ds_read_b128 v[76:79], v38
    v_mfma_f32_16x16x32_bf16 v[144:147], v[100:103], v[68:71], v[144:147]
    ds_read_b64 v[116:117], v36 offset:1472
    v_mfma_f32_16x16x32_bf16 v[140:143], v[100:103], v[64:67], v[140:143]
    ds_read_b64 v[118:119], v36 offset:1480
    v_mfma_f32_16x16x32_bf16 v[136:139], v[100:103], v[60:63], v[136:139]
    ds_read_b64 v[120:121], v36 offset:960
    v_mfma_f32_16x16x32_bf16 v[132:135], v[100:103], v[56:59], v[132:135]
    ds_read_b64 v[122:123], v36 offset:968
    s_waitcnt lgkmcnt(15)
    v_mfma_f32_16x16x32_bf16 v[156:159], v[104:107], v[44:47], v[156:159]
    ds_read_b128 v[44:47], v37 offset:2432
    v_mfma_f32_16x16x32_bf16 v[152:155], v[104:107], v[72:75], v[152:155]
    ds_read_b64 v[124:125], v36 offset:448
    v_mfma_f32_16x16x32_bf16 v[148:151], v[104:107], v[68:71], v[148:151]
    ds_read_b64 v[126:127], v36 offset:456
    v_mfma_f32_16x16x32_bf16 v[144:147], v[104:107], v[64:67], v[144:147]
    ds_read_b128 v[204:207], v37 offset:448
    v_mfma_f32_16x16x32_bf16 v[140:143], v[104:107], v[60:63], v[140:143]
    ds_read_b128 v[208:211], v37 offset:432
    v_mfma_f32_16x16x32_bf16 v[136:139], v[104:107], v[56:59], v[136:139]
    ds_read_b128 v[212:215], v37 offset:1472
    v_mfma_f32_16x16x32_bf16 v[156:159], v[108:111], v[72:75], v[156:159]
    ds_read_b128 v[216:219], v37 offset:1456
    v_mfma_f32_16x16x32_bf16 v[152:155], v[108:111], v[68:71], v[152:155]
    v_mfma_f32_16x16x32_bf16 v[148:151], v[108:111], v[64:67], v[148:151]
    v_mfma_f32_16x16x32_bf16 v[144:147], v[108:111], v[60:63], v[144:147]
    v_mfma_f32_16x16x32_bf16 v[140:143], v[108:111], v[56:59], v[140:143]
    s_waitcnt lgkmcnt(15)
    v_mfma_f32_16x16x32_bf16 v[156:159], v[14:17], v[68:71], v[156:159]
    v_mfma_f32_16x16x32_bf16 v[152:155], v[14:17], v[64:67], v[152:155]
    v_mfma_f32_16x16x32_bf16 v[148:151], v[14:17], v[60:63], v[148:151]
    v_mfma_f32_16x16x32_bf16 v[144:147], v[14:17], v[56:59], v[144:147]
    s_waitcnt lgkmcnt(3)
    v_mfma_f32_16x16x32_bf16 v[220:223], v[204:207], v[180:183], 0
    ds_read_b64 v[96:97], v36 offset:1920
    s_waitcnt lgkmcnt(3)
    v_mfma_f32_16x16x32_bf16 v[224:227], v[208:211], v[184:187], 0
    ds_read_b64 v[98:99], v36 offset:1928
    s_waitcnt lgkmcnt(3)
    v_mfma_f32_16x16x32_bf16 v[228:231], v[212:215], v[180:183], 0
    ds_read_b128 v[72:75], v37 offset:1856
    s_waitcnt lgkmcnt(3)
    v_mfma_f32_16x16x32_bf16 v[232:235], v[216:219], v[184:187], 0
    ds_read_b128 v[68:71], v37 offset:1344
    v_mfma_f32_16x16x32_bf16 v[156:159], v[112:115], v[52:55], v[156:159]
    ds_read_b128 v[52:55], v37 offset:3392
    v_mfma_f32_16x16x32_bf16 v[152:155], v[112:115], v[48:51], v[152:155]
    ds_read_b128 v[64:67], v37 offset:832
    v_mfma_f32_16x16x32_bf16 v[148:151], v[112:115], v[44:47], v[148:151]
    ds_read_b128 v[60:63], v37 offset:320
    v_mfma_f32_16x16x32_bf16 v[144:147], v[112:115], v[92:95], v[144:147]
    v_subrev_u32 v38, 192, v37
    v_mfma_f32_16x16x32_bf16 v[140:143], v[112:115], v[88:91], v[140:143]
    v_max_i32 v38, s42, v38
    v_mfma_f32_16x16x32_bf16 v[136:139], v[112:115], v[84:87], v[136:139]
    ds_read_b128 v[56:59], v38
    v_mfma_f32_16x16x32_bf16 v[132:135], v[112:115], v[80:83], v[132:135]
    ds_read_b64 v[100:101], v36 offset:1408
    v_mfma_f32_16x16x32_bf16 v[128:131], v[112:115], v[76:79], v[128:131]
    ds_read_b64 v[102:103], v36 offset:1416
    v_mfma_f32_16x16x32_bf16 v[156:159], v[116:119], v[48:51], v[156:159]
    ds_read_b128 v[48:51], v37 offset:2880
    v_mfma_f32_16x16x32_bf16 v[152:155], v[116:119], v[44:47], v[152:155]
    ds_read_b64 v[104:105], v36 offset:896
    v_mfma_f32_16x16x32_bf16 v[148:151], v[116:119], v[92:95], v[148:151]
    ds_read_b64 v[106:107], v36 offset:904
    v_mfma_f32_16x16x32_bf16 v[144:147], v[116:119], v[88:91], v[144:147]
    ds_read_b64 v[108:109], v36 offset:384
    v_mfma_f32_16x16x32_bf16 v[140:143], v[116:119], v[84:87], v[140:143]
    ds_read_b64 v[110:111], v36 offset:392
    v_mfma_f32_16x16x32_bf16 v[136:139], v[116:119], v[80:83], v[136:139]
    v_mfma_f32_16x16x32_bf16 v[132:135], v[116:119], v[76:79], v[132:135]
    v_mfma_f32_16x16x32_bf16 v[156:159], v[120:123], v[44:47], v[156:159]
    ds_read_b128 v[44:47], v37 offset:2368
    v_mfma_f32_16x16x32_bf16 v[152:155], v[120:123], v[92:95], v[152:155]
    v_mfma_f32_16x16x32_bf16 v[148:151], v[120:123], v[88:91], v[148:151]
    v_mfma_f32_16x16x32_bf16 v[144:147], v[120:123], v[84:87], v[144:147]
    v_mfma_f32_16x16x32_bf16 v[140:143], v[120:123], v[80:83], v[140:143]
    v_mfma_f32_16x16x32_bf16 v[136:139], v[120:123], v[76:79], v[136:139]
    v_mfma_f32_16x16x32_bf16 v[156:159], v[124:127], v[92:95], v[156:159]
    v_mfma_f32_16x16x32_bf16 v[152:155], v[124:127], v[88:91], v[152:155]
    v_mfma_f32_16x16x32_bf16 v[148:151], v[124:127], v[84:87], v[148:151]
    v_mfma_f32_16x16x32_bf16 v[144:147], v[124:127], v[80:83], v[144:147]
    v_mfma_f32_16x16x32_bf16 v[140:143], v[124:127], v[76:79], v[140:143]
    s_waitcnt lgkmcnt(11)
    v_mfma_f32_16x16x32_bf16 v[156:159], v[96:99], v[52:55], v[156:159]
    ds_read_b128 v[52:55], v37 offset:3328
    s_waitcnt lgkmcnt(6)
    v_mfma_f32_16x16x32_bf16 v[152:155], v[96:99], v[48:51], v[152:155]
    ds_read_b64 v[112:113], v36 offset:1856
    s_waitcnt lgkmcnt(2)
    v_mfma_f32_16x16x32_bf16 v[148:151], v[96:99], v[44:47], v[148:151]
    ds_read_b64 v[114:115], v36 offset:1864
    v_mfma_f32_16x16x32_bf16 v[144:147], v[96:99], v[72:75], v[144:147]
    ds_read_b128 v[92:95], v37 offset:1792
    v_mfma_f32_16x16x32_bf16 v[140:143], v[96:99], v[68:71], v[140:143]
    ds_read_b128 v[88:91], v37 offset:1280
    v_mfma_f32_16x16x32_bf16 v[136:139], v[96:99], v[64:67], v[136:139]
    ds_read_b128 v[84:87], v37 offset:768
    v_mfma_f32_16x16x32_bf16 v[132:135], v[96:99], v[60:63], v[132:135]
    ds_read_b128 v[80:83], v37 offset:256
    v_mfma_f32_16x16x32_bf16 v[128:131], v[96:99], v[56:59], v[128:131]
    v_subrev_u32 v38, 256, v37
    v_mfma_f32_16x16x32_bf16 v[156:159], v[100:103], v[48:51], v[156:159]
    ds_read_b128 v[48:51], v37 offset:2816
    v_mfma_f32_16x16x32_bf16 v[152:155], v[100:103], v[44:47], v[152:155]
    v_max_i32 v38, s42, v38
    v_mfma_f32_16x16x32_bf16 v[148:151], v[100:103], v[72:75], v[148:151]
    ds_read_b128 v[76:79], v38
    v_mfma_f32_16x16x32_bf16 v[144:147], v[100:103], v[68:71], v[144:147]
    ds_read_b64 v[116:117], v36 offset:1344
    v_mfma_f32_16x16x32_bf16 v[140:143], v[100:103], v[64:67], v[140:143]
    ds_read_b64 v[118:119], v36 offset:1352
    v_mfma_f32_16x16x32_bf16 v[136:139], v[100:103], v[60:63], v[136:139]
    ds_read_b64 v[120:121], v36 offset:832
    v_mfma_f32_16x16x32_bf16 v[132:135], v[100:103], v[56:59], v[132:135]
    ds_read_b64 v[122:123], v36 offset:840
    v_mfma_f32_16x16x32_bf16 v[156:159], v[104:107], v[44:47], v[156:159]
    ds_read_b128 v[44:47], v37 offset:2304
    v_mfma_f32_16x16x32_bf16 v[152:155], v[104:107], v[72:75], v[152:155]
    ds_read_b64 v[124:125], v36 offset:320
    v_mfma_f32_16x16x32_bf16 v[148:151], v[104:107], v[68:71], v[148:151]
    ds_read_b64 v[126:127], v36 offset:328
    v_mfma_f32_16x16x32_bf16 v[144:147], v[104:107], v[64:67], v[144:147]
    v_cvt_pk_bf16_f32 v236, v220, v221
    v_mfma_f32_16x16x32_bf16 v[140:143], v[104:107], v[60:63], v[140:143]
    v_cvt_pk_bf16_f32 v237, v222, v223
    v_mfma_f32_16x16x32_bf16 v[136:139], v[104:107], v[56:59], v[136:139]
    v_cvt_pk_bf16_f32 v238, v224, v225
    v_mfma_f32_16x16x32_bf16 v[156:159], v[108:111], v[72:75], v[156:159]
    v_cvt_pk_bf16_f32 v239, v226, v227
    v_mfma_f32_16x16x32_bf16 v[152:155], v[108:111], v[68:71], v[152:155]
    v_cvt_pk_bf16_f32 v240, v228, v229
    v_mfma_f32_16x16x32_bf16 v[148:151], v[108:111], v[64:67], v[148:151]
    v_cvt_pk_bf16_f32 v241, v230, v231
    v_mfma_f32_16x16x32_bf16 v[144:147], v[108:111], v[60:63], v[144:147]
    v_cvt_pk_bf16_f32 v242, v232, v233
    v_mfma_f32_16x16x32_bf16 v[140:143], v[108:111], v[56:59], v[140:143]
    v_cvt_pk_bf16_f32 v243, v234, v235
    s_waitcnt lgkmcnt(13)
    v_mfma_f32_16x16x32_bf16 v[156:159], v[112:115], v[52:55], v[156:159]
    ds_read_b128 v[52:55], v37 offset:3264
    s_waitcnt lgkmcnt(9)
    v_mfma_f32_16x16x32_bf16 v[152:155], v[112:115], v[48:51], v[152:155]
    ds_read_b64 v[96:97], v36 offset:1792
    s_waitcnt lgkmcnt(4)
    v_mfma_f32_16x16x32_bf16 v[148:151], v[112:115], v[44:47], v[148:151]
    ds_read_b64 v[98:99], v36 offset:1800
    v_mfma_f32_16x16x32_bf16 v[144:147], v[112:115], v[92:95], v[144:147]
    ds_read_b128 v[72:75], v37 offset:1728
    v_mfma_f32_16x16x32_bf16 v[140:143], v[112:115], v[88:91], v[140:143]
    ds_read_b128 v[68:71], v37 offset:1216
    v_mfma_f32_16x16x32_bf16 v[136:139], v[112:115], v[84:87], v[136:139]
    ds_read_b128 v[64:67], v37 offset:704
    v_mfma_f32_16x16x32_bf16 v[132:135], v[112:115], v[80:83], v[132:135]
    ds_read_b128 v[60:63], v37 offset:192
    v_mfma_f32_16x16x32_bf16 v[128:131], v[112:115], v[76:79], v[128:131]
    v_subrev_u32 v38, 320, v37
    v_mfma_f32_16x16x32_bf16 v[156:159], v[116:119], v[48:51], v[156:159]
    ds_read_b128 v[48:51], v37 offset:2752
    v_mfma_f32_16x16x32_bf16 v[152:155], v[116:119], v[44:47], v[152:155]
    v_max_i32 v38, s42, v38
    v_mfma_f32_16x16x32_bf16 v[148:151], v[116:119], v[92:95], v[148:151]
    ds_read_b128 v[56:59], v38
    v_mfma_f32_16x16x32_bf16 v[144:147], v[116:119], v[88:91], v[144:147]
    ds_read_b64 v[100:101], v36 offset:1280
    v_mfma_f32_16x16x32_bf16 v[140:143], v[116:119], v[84:87], v[140:143]
    ds_read_b64 v[102:103], v36 offset:1288
    v_mfma_f32_16x16x32_bf16 v[136:139], v[116:119], v[80:83], v[136:139]
    ds_read_b64 v[104:105], v36 offset:768
    v_mfma_f32_16x16x32_bf16 v[132:135], v[116:119], v[76:79], v[132:135]
    ds_read_b64 v[106:107], v36 offset:776
    v_mfma_f32_16x16x32_bf16 v[156:159], v[120:123], v[44:47], v[156:159]
    ds_read_b128 v[44:47], v37 offset:2240
    v_mfma_f32_16x16x32_bf16 v[152:155], v[120:123], v[92:95], v[152:155]
    ds_read_b64 v[108:109], v36 offset:256
    v_mfma_f32_16x16x32_bf16 v[148:151], v[120:123], v[88:91], v[148:151]
    ds_read_b64 v[110:111], v36 offset:264
    v_mfma_f32_16x16x32_bf16 v[144:147], v[120:123], v[84:87], v[144:147]
    v_mfma_f32_16x16x32_bf16 v[140:143], v[120:123], v[80:83], v[140:143]
    v_mfma_f32_16x16x32_bf16 v[136:139], v[120:123], v[76:79], v[136:139]
    s_waitcnt lgkmcnt(15)
    v_mfma_f32_16x16x32_bf16 v[156:159], v[124:127], v[92:95], v[156:159]
    v_mfma_f32_16x16x32_bf16 v[152:155], v[124:127], v[88:91], v[152:155]
    v_mfma_f32_16x16x32_bf16 v[148:151], v[124:127], v[84:87], v[148:151]
    v_mfma_f32_16x16x32_bf16 v[144:147], v[124:127], v[80:83], v[144:147]
    v_mfma_f32_16x16x32_bf16 v[140:143], v[124:127], v[76:79], v[140:143]
    v_mfma_f32_16x16x32_bf16 v[148:151], v[236:239], v[188:191], v[148:151]
    v_mfma_f32_16x16x32_bf16 v[152:155], v[236:239], v[192:195], v[152:155]
    v_mfma_f32_16x16x32_bf16 v[156:159], v[236:239], v[196:199], v[156:159]
    v_mfma_f32_16x16x32_bf16 v[156:159], v[240:243], v[188:191], v[156:159]
    s_cmp_eq_u32 s60, 1
    s_cbranch_scc1 A_red0
A_c4:
    s_waitcnt lgkmcnt(13)
    v_mfma_f32_16x16x32_bf16 v[156:159], v[96:99], v[52:55], v[156:159]
    ds_read_b128 v[52:55], v37 offset:3200
    s_waitcnt lgkmcnt(9)
    v_mfma_f32_16x16x32_bf16 v[152:155], v[96:99], v[48:51], v[152:155]
    ds_read_b64 v[112:113], v36 offset:1728
    s_waitcnt lgkmcnt(4)
    v_mfma_f32_16x16x32_bf16 v[148:151], v[96:99], v[44:47], v[148:151]
    ds_read_b64 v[114:115], v36 offset:1736
    v_mfma_f32_16x16x32_bf16 v[144:147], v[96:99], v[72:75], v[144:147]
    ds_read_b128 v[92:95], v37 offset:1664
    v_mfma_f32_16x16x32_bf16 v[140:143], v[96:99], v[68:71], v[140:143]
    ds_read_b128 v[88:91], v37 offset:1152
    v_mfma_f32_16x16x32_bf16 v[136:139], v[96:99], v[64:67], v[136:139]
    ds_read_b128 v[84:87], v37 offset:640
    v_mfma_f32_16x16x32_bf16 v[132:135], v[96:99], v[60:63], v[132:135]
    ds_read_b128 v[80:83], v37 offset:128
    v_mfma_f32_16x16x32_bf16 v[128:131], v[96:99], v[56:59], v[128:131]
    v_subrev_u32 v38, 384, v37
    v_mfma_f32_16x16x32_bf16 v[156:159], v[100:103], v[48:51], v[156:159]
    ds_read_b128 v[48:51], v37 offset:2688
    v_mfma_f32_16x16x32_bf16 v[152:155], v[100:103], v[44:47], v[152:155]
    v_max_i32 v38, s42, v38
    v_mfma_f32_16x16x32_bf16 v[148:151], v[100:103], v[72:75], v[148:151]
    ds_read_b128 v[76:79], v38
    v_mfma_f32_16x16x32_bf16 v[144:147], v[100:103], v[68:71], v[144:147]
    ds_read_b64 v[116:117], v36 offset:1216
    v_mfma_f32_16x16x32_bf16 v[140:143], v[100:103], v[64:67], v[140:143]
    ds_read_b64 v[118:119], v36 offset:1224
    v_mfma_f32_16x16x32_bf16 v[136:139], v[100:103], v[60:63], v[136:139]
    ds_read_b64 v[120:121], v36 offset:704
    v_mfma_f32_16x16x32_bf16 v[132:135], v[100:103], v[56:59], v[132:135]
    ds_read_b64 v[122:123], v36 offset:712
    v_mfma_f32_16x16x32_bf16 v[156:159], v[104:107], v[44:47], v[156:159]
    ds_read_b128 v[44:47], v37 offset:2176
    v_mfma_f32_16x16x32_bf16 v[152:155], v[104:107], v[72:75], v[152:155]
    ds_read_b64 v[124:125], v36 offset:192
    v_mfma_f32_16x16x32_bf16 v[148:151], v[104:107], v[68:71], v[148:151]
    ds_read_b64 v[126:127], v36 offset:200
    v_mfma_f32_16x16x32_bf16 v[144:147], v[104:107], v[64:67], v[144:147]
    v_subrev_u32 v40, 64, v37
    v_mfma_f32_16x16x32_bf16 v[140:143], v[104:107], v[60:63], v[140:143]
    v_max_i32 v40, s42, v40
    v_mfma_f32_16x16x32_bf16 v[136:139], v[104:107], v[56:59], v[136:139]
    ds_read_b128 v[204:207], v40
    s_waitcnt lgkmcnt(15)
    v_mfma_f32_16x16x32_bf16 v[156:159], v[108:111], v[72:75], v[156:159]
    v_subrev_u32 v40, 80, v37
    v_mfma_f32_16x16x32_bf16 v[152:155], v[108:111], v[68:71], v[152:155]
    v_max_i32 v40, s42, v40
    v_mfma_f32_16x16x32_bf16 v[148:151], v[108:111], v[64:67], v[148:151]
    ds_read_b128 v[208:211], v40
    v_mfma_f32_16x16x32_bf16 v[144:147], v[108:111], v[60:63], v[144:147]
    ds_read_b128 v[212:215], v37 offset:960
    v_mfma_f32_16x16x32_bf16 v[140:143], v[108:111], v[56:59], v[140:143]
    ds_read_b128 v[216:219], v37 offset:944
    s_waitcnt lgkmcnt(3)
    v_mfma_f32_16x16x32_bf16 v[220:223], v[204:207], v[180:183], 0
    ds_read_b64 v[96:97], v36 offset:1664
    s_waitcnt lgkmcnt(3)
    v_mfma_f32_16x16x32_bf16 v[224:227], v[208:211], v[184:187], 0
    ds_read_b64 v[98:99], v36 offset:1672
    s_waitcnt lgkmcnt(3)
    v_mfma_f32_16x16x32_bf16 v[228:231], v[212:215], v[180:183], 0
    ds_read_b128 v[72:75], v37 offset:1600
    s_waitcnt lgkmcnt(3)
    v_mfma_f32_16x16x32_bf16 v[232:235], v[216:219], v[184:187], 0
    ds_read_b128 v[68:71], v37 offset:1088
    v_mfma_f32_16x16x32_bf16 v[156:159], v[112:115], v[52:55], v[156:159]
    ds_read_b128 v[52:55], v37 offset:3136
    v_mfma_f32_16x16x32_bf16 v[152:155], v[112:115], v[48:51], v[152:155]
    ds_read_b128 v[64:67], v37 offset:576
    v_mfma_f32_16x16x32_bf16 v[148:151], v[112:115], v[44:47], v[148:151]
    ds_read_b128 v[60:63], v37 offset:64
    v_mfma_f32_16x16x32_bf16 v[144:147], v[112:115], v[92:95], v[144:147]
    v_subrev_u32 v38, 448, v37
    v_mfma_f32_16x16x32_bf16 v[140:143], v[112:115], v[88:91], v[140:143]
    v_max_i32 v38, s42, v38
    v_mfma_f32_16x16x32_bf16 v[136:139], v[112:115], v[84:87], v[136:139]
    ds_read_b128 v[56:59], v38
    v_mfma_f32_16x16x32_bf16 v[132:135], v[112:115], v[80:83], v[132:135]
    ds_read_b64 v[100:101], v36 offset:1152
    v_mfma_f32_16x16x32_bf16 v[128:131], v[112:115], v[76:79], v[128:131]
    ds_read_b64 v[102:103], v36 offset:1160
    v_mfma_f32_16x16x32_bf16 v[156:159], v[116:119], v[48:51], v[156:159]
    ds_read_b128 v[48:51], v37 offset:2624
    v_mfma_f32_16x16x32_bf16 v[152:155], v[116:119], v[44:47], v[152:155]
    ds_read_b64 v[104:105], v36 offset:640
    v_mfma_f32_16x16x32_bf16 v[148:151], v[116:119], v[92:95], v[148:151]
    ds_read_b64 v[106:107], v36 offset:648
    v_mfma_f32_16x16x32_bf16 v[144:147], v[116:119], v[88:91], v[144:147]
    ds_read_b64 v[108:109], v36 offset:128
    v_mfma_f32_16x16x32_bf16 v[140:143], v[116:119], v[84:87], v[140:143]
    ds_read_b64 v[110:111], v36 offset:136
    v_mfma_f32_16x16x32_bf16 v[136:139], v[116:119], v[80:83], v[136:139]
    v_mfma_f32_16x16x32_bf16 v[132:135], v[116:119], v[76:79], v[132:135]
    v_mfma_f32_16x16x32_bf16 v[156:159], v[120:123], v[44:47], v[156:159]
    ds_read_b128 v[44:47], v37 offset:2112
    v_mfma_f32_16x16x32_bf16 v[152:155], v[120:123], v[92:95], v[152:155]
    v_mfma_f32_16x16x32_bf16 v[148:151], v[120:123], v[88:91], v[148:151]
    v_mfma_f32_16x16x32_bf16 v[144:147], v[120:123], v[84:87], v[144:147]
    v_mfma_f32_16x16x32_bf16 v[140:143], v[120:123], v[80:83], v[140:143]
    v_mfma_f32_16x16x32_bf16 v[136:139], v[120:123], v[76:79], v[136:139]
    v_mfma_f32_16x16x32_bf16 v[156:159], v[124:127], v[92:95], v[156:159]
    v_mfma_f32_16x16x32_bf16 v[152:155], v[124:127], v[88:91], v[152:155]
    v_mfma_f32_16x16x32_bf16 v[148:151], v[124:127], v[84:87], v[148:151]
    v_mfma_f32_16x16x32_bf16 v[144:147], v[124:127], v[80:83], v[144:147]
    v_mfma_f32_16x16x32_bf16 v[140:143], v[124:127], v[76:79], v[140:143]
    s_waitcnt lgkmcnt(11)
    v_mfma_f32_16x16x32_bf16 v[156:159], v[96:99], v[52:55], v[156:159]
    ds_read_b128 v[52:55], v37 offset:3072
    s_waitcnt lgkmcnt(6)
    v_mfma_f32_16x16x32_bf16 v[152:155], v[96:99], v[48:51], v[152:155]
    ds_read_b64 v[112:113], v36 offset:1600
    s_waitcnt lgkmcnt(2)
    v_mfma_f32_16x16x32_bf16 v[148:151], v[96:99], v[44:47], v[148:151]
    ds_read_b64 v[114:115], v36 offset:1608
    v_mfma_f32_16x16x32_bf16 v[144:147], v[96:99], v[72:75], v[144:147]
    ds_read_b128 v[92:95], v37 offset:1536
    v_mfma_f32_16x16x32_bf16 v[140:143], v[96:99], v[68:71], v[140:143]
    ds_read_b128 v[88:91], v37 offset:1024
    v_mfma_f32_16x16x32_bf16 v[136:139], v[96:99], v[64:67], v[136:139]
    ds_read_b128 v[84:87], v37 offset:512
    v_mfma_f32_16x16x32_bf16 v[132:135], v[96:99], v[60:63], v[132:135]
    ds_read_b128 v[80:83], v37 offset:0
    v_mfma_f32_16x16x32_bf16 v[128:131], v[96:99], v[56:59], v[128:131]
    v_subrev_u32 v38, 512, v37
    v_mfma_f32_16x16x32_bf16 v[156:159], v[100:103], v[48:51], v[156:159]
    ds_read_b128 v[48:51], v37 offset:2560
    v_mfma_f32_16x16x32_bf16 v[152:155], v[100:103], v[44:47], v[152:155]
    v_max_i32 v38, s42, v38
    v_mfma_f32_16x16x32_bf16 v[148:151], v[100:103], v[72:75], v[148:151]
    ds_read_b128 v[76:79], v38
    v_mfma_f32_16x16x32_bf16 v[144:147], v[100:103], v[68:71], v[144:147]
    ds_read_b64 v[116:117], v36 offset:1088
    v_mfma_f32_16x16x32_bf16 v[140:143], v[100:103], v[64:67], v[140:143]
    ds_read_b64 v[118:119], v36 offset:1096
    v_mfma_f32_16x16x32_bf16 v[136:139], v[100:103], v[60:63], v[136:139]
    ds_read_b64 v[120:121], v36 offset:576
    v_mfma_f32_16x16x32_bf16 v[132:135], v[100:103], v[56:59], v[132:135]
    ds_read_b64 v[122:123], v36 offset:584
    v_mfma_f32_16x16x32_bf16 v[156:159], v[104:107], v[44:47], v[156:159]
    ds_read_b128 v[44:47], v37 offset:2048
    v_mfma_f32_16x16x32_bf16 v[152:155], v[104:107], v[72:75], v[152:155]
    ds_read_b64 v[124:125], v36 offset:64
    v_mfma_f32_16x16x32_bf16 v[148:151], v[104:107], v[68:71], v[148:151]
    ds_read_b64 v[126:127], v36 offset:72
    v_mfma_f32_16x16x32_bf16 v[144:147], v[104:107], v[64:67], v[144:147]
    v_cvt_pk_bf16_f32 v236, v220, v221
    v_mfma_f32_16x16x32_bf16 v[140:143], v[104:107], v[60:63], v[140:143]
    v_cvt_pk_bf16_f32 v237, v222, v223
    v_mfma_f32_16x16x32_bf16 v[136:139], v[104:107], v[56:59], v[136:139]
    v_cvt_pk_bf16_f32 v238, v224, v225
    v_mfma_f32_16x16x32_bf16 v[156:159], v[108:111], v[72:75], v[156:159]
    v_cvt_pk_bf16_f32 v239, v226, v227
    v_mfma_f32_16x16x32_bf16 v[152:155], v[108:111], v[68:71], v[152:155]
    v_cvt_pk_bf16_f32 v240, v228, v229
    v_mfma_f32_16x16x32_bf16 v[148:151], v[108:111], v[64:67], v[148:151]
    v_cvt_pk_bf16_f32 v241, v230, v231
    v_mfma_f32_16x16x32_bf16 v[144:147], v[108:111], v[60:63], v[144:147]
    v_cvt_pk_bf16_f32 v242, v232, v233
    v_mfma_f32_16x16x32_bf16 v[140:143], v[108:111], v[56:59], v[140:143]
    v_cvt_pk_bf16_f32 v243, v234, v235
    s_waitcnt lgkmcnt(13)
    v_mfma_f32_16x16x32_bf16 v[156:159], v[112:115], v[52:55], v[156:159]
    s_waitcnt lgkmcnt(8)
    v_mfma_f32_16x16x32_bf16 v[152:155], v[112:115], v[48:51], v[152:155]
    s_waitcnt lgkmcnt(2)
    v_mfma_f32_16x16x32_bf16 v[148:151], v[112:115], v[44:47], v[148:151]
    v_mfma_f32_16x16x32_bf16 v[144:147], v[112:115], v[92:95], v[144:147]
    v_mfma_f32_16x16x32_bf16 v[140:143], v[112:115], v[88:91], v[140:143]
    v_mfma_f32_16x16x32_bf16 v[136:139], v[112:115], v[84:87], v[136:139]
    v_mfma_f32_16x16x32_bf16 v[132:135], v[112:115], v[80:83], v[132:135]
    v_mfma_f32_16x16x32_bf16 v[128:131], v[112:115], v[76:79], v[128:131]
    v_mfma_f32_16x16x32_bf16 v[156:159], v[116:119], v[48:51], v[156:159]
    v_mfma_f32_16x16x32_bf16 v[152:155], v[116:119], v[44:47], v[152:155]
    v_mfma_f32_16x16x32_bf16 v[148:151], v[116:119], v[92:95], v[148:151]
    v_mfma_f32_16x16x32_bf16 v[144:147], v[116:119], v[88:91], v[144:147]
    v_mfma_f32_16x16x32_bf16 v[140:143], v[116:119], v[84:87], v[140:143]
    v_mfma_f32_16x16x32_bf16 v[136:139], v[116:119], v[80:83], v[136:139]
    v_mfma_f32_16x16x32_bf16 v[132:135], v[116:119], v[76:79], v[132:135]
    v_mfma_f32_16x16x32_bf16 v[156:159], v[120:123], v[44:47], v[156:159]
    v_mfma_f32_16x16x32_bf16 v[152:155], v[120:123], v[92:95], v[152:155]
    v_mfma_f32_16x16x32_bf16 v[148:151], v[120:123], v[88:91], v[148:151]
    v_mfma_f32_16x16x32_bf16 v[144:147], v[120:123], v[84:87], v[144:147]
    v_mfma_f32_16x16x32_bf16 v[140:143], v[120:123], v[80:83], v[140:143]
    v_mfma_f32_16x16x32_bf16 v[136:139], v[120:123], v[76:79], v[136:139]
    s_waitcnt lgkmcnt(0)
    v_mfma_f32_16x16x32_bf16 v[156:159], v[124:127], v[92:95], v[156:159]
    v_mfma_f32_16x16x32_bf16 v[152:155], v[124:127], v[88:91], v[152:155]
    v_mfma_f32_16x16x32_bf16 v[148:151], v[124:127], v[84:87], v[148:151]
    v_mfma_f32_16x16x32_bf16 v[144:147], v[124:127], v[80:83], v[144:147]
    v_mfma_f32_16x16x32_bf16 v[140:143], v[124:127], v[76:79], v[140:143]
    v_mfma_f32_16x16x32_bf16 v[144:147], v[236:239], v[188:191], v[144:147]
    v_mfma_f32_16x16x32_bf16 v[148:151], v[236:239], v[192:195], v[148:151]
    v_mfma_f32_16x16x32_bf16 v[152:155], v[236:239], v[196:199], v[152:155]
    v_mfma_f32_16x16x32_bf16 v[156:159], v[236:239], v[200:203], v[156:159]
    v_mfma_f32_16x16x32_bf16 v[152:155], v[240:243], v[188:191], v[152:155]
    v_mfma_f32_16x16x32_bf16 v[156:159], v[240:243], v[192:195], v[156:159]
    s_cmp_eq_u32 s60, 0
    s_cbranch_scc1 A_lo
    s_setprio 3
    v_lshl_add_u32 v4, v1, 4, s62
    s_nop 7
    ds_write_b128 v4, v[128:131] offset:4096
    ds_write_b128 v4, v[132:135] offset:5120
    ds_write_b128 v4, v[136:139] offset:6144
    ds_write_b128 v4, v[140:143] offset:7168
    s_waitcnt lgkmcnt(0)
    s_barrier
    ds_read_b128 v[96:99], v4 offset:0
    ds_read_b128 v[100:103], v4 offset:1024
    ds_read_b128 v[104:107], v4 offset:2048
    ds_read_b128 v[108:111], v4 offset:3072
    s_waitcnt lgkmcnt(3)
    v_add_f32 v144, v144, v96
    v_add_f32 v145, v145, v97
    v_add_f32 v146, v146, v98
    v_add_f32 v147, v147, v99
    s_waitcnt lgkmcnt(2)
    v_add_f32 v148, v148, v100
    v_add_f32 v149, v149, v101
    v_add_f32 v150, v150, v102
    v_add_f32 v151, v151, v103
    s_waitcnt lgkmcnt(1)
    v_add_f32 v152, v152, v104
    v_add_f32 v153, v153, v105
    v_add_f32 v154, v154, v106
    v_add_f32 v155, v155, v107
    s_waitcnt lgkmcnt(0)
    v_add_f32 v156, v156, v108
    v_add_f32 v157, v157, v109
    v_add_f32 v158, v158, v110
    v_add_f32 v159, v159, v111
    s_branch A_hi
A_red0:
    s_setprio 3
    v_lshl_add_u32 v4, v1, 4, s62
    s_nop 7
    ds_write_b128 v4, v[144:147] offset:0
    ds_write_b128 v4, v[148:151] offset:1024
    ds_write_b128 v4, v[152:155] offset:2048
    ds_write_b128 v4, v[156:159] offset:3072
    s_waitcnt lgkmcnt(0)
    s_barrier
    ds_read_b128 v[96:99], v4 offset:4096
    ds_read_b128 v[100:103], v4 offset:5120
    ds_read_b128 v[104:107], v4 offset:6144
    ds_read_b128 v[108:111], v4 offset:7168
    s_waitcnt lgkmcnt(3)
    v_add_f32 v128, v128, v96
    v_add_f32 v129, v129, v97
    v_add_f32 v130, v130, v98
    v_add_f32 v131, v131, v99
    s_waitcnt lgkmcnt(2)
    v_add_f32 v132, v132, v100
    v_add_f32 v133, v133, v101
    v_add_f32 v134, v134, v102
    v_add_f32 v135, v135, v103
    s_waitcnt lgkmcnt(1)
    v_add_f32 v136, v136, v104
    v_add_f32 v137, v137, v105
    v_add_f32 v138, v138, v106
    v_add_f32 v139, v139, v107
    s_waitcnt lgkmcnt(0)
    v_add_f32 v140, v140, v108
    v_add_f32 v141, v141, v109
    v_add_f32 v142, v142, v110
    v_add_f32 v143, v143, v111
A_lo:
    v_cvt_pk_bf16_f32 v44, v128, v129
    v_cvt_pk_bf16_f32 v45, v130, v131
    v_cvt_pk_bf16_f32 v46, v132, v133
    v_cvt_pk_bf16_f32 v47, v134, v135
    s_nop 0
    v_permlane16_swap_b32 v44, v46
    v_permlane16_swap_b32 v45, v47
    global_store_dwordx4 v39, v[44:47], s[38:39] offset:0 sc1
    v_cvt_pk_bf16_f32 v48, v136, v137
    v_cvt_pk_bf16_f32 v49, v138, v139
    v_cvt_pk_bf16_f32 v50, v140, v141
    v_cvt_pk_bf16_f32 v51, v142, v143
    s_nop 0
    v_permlane16_swap_b32 v48, v50
    v_permlane16_swap_b32 v49, v51
    global_store_dwordx4 v39, v[48:51], s[38:39] offset:1024 sc1
    s_cmp_eq_u32 s60, 1
    s_cbranch_scc1 A_sig
A_hi:
    v_cvt_pk_bf16_f32 v52, v144, v145
    v_cvt_pk_bf16_f32 v53, v146, v147
    v_cvt_pk_bf16_f32 v54, v148, v149
    v_cvt_pk_bf16_f32 v55, v150, v151
    s_nop 0
    v_permlane16_swap_b32 v52, v54
    v_permlane16_swap_b32 v53, v55
    global_store_dwordx4 v39, v[52:55], s[38:39] offset:2048 sc1
    v_cvt_pk_bf16_f32 v56, v152, v153
    v_cvt_pk_bf16_f32 v57, v154, v155
    v_cvt_pk_bf16_f32 v58, v156, v157
    v_cvt_pk_bf16_f32 v59, v158, v159
    s_nop 0
    v_permlane16_swap_b32 v56, v58
    v_permlane16_swap_b32 v57, v59
    global_store_dwordx4 v39, v[56:59], s[38:39] offset:3072 sc1
A_sig:
    s_lshr_b32 s46, s41, 1
    s_lshl_b32 s46, s46, 7
    s_add_u32 s46, s46, 6468608
    v_lshl_add_u32 v4, v1, 7, s46
    v_mov_b32 v5, 1
    s_waitcnt vmcnt(0)
    s_barrier
    s_cmp_lg_u32 s40, 0
    s_cbranch_scc1 A_end
    s_cmp_eq_u32 s60, 1
    s_cselect_b64 exec, 1, 3
    global_store_dword v4, v5, s[38:39] sc1
A_end:
    s_endpgm
X_exit:
    s_endpgm
.section .rodata,"a"
.p2align 6
.amdhsa_kernel gated_mix__ssm_conv_s4__linear_attn_block__prompt_kernel
  .amdhsa_next_free_vgpr 256
  .amdhsa_next_free_sgpr 96
  .amdhsa_accum_offset 256
  .amdhsa_group_segment_fixed_size 0
  .amdhsa_kernarg_size 128
  .amdhsa_user_sgpr_count 2
  .amdhsa_user_sgpr_kernarg_segment_ptr 1
  .amdhsa_system_sgpr_workgroup_id_x 1
.end_amdhsa_kernel
```
